```python
import torch

def _softmax(x, axis=-1):
    return torch.softmax(x, dim=axis)
def _gelu(x):
    return torch.nn.functional.gelu(x, approximate="tanh")
def _silu(x):
    return torch.nn.functional.silu(x)
def _sigmoid(x):
    return torch.sigmoid(x)
def _layernorm(x, axis=-1, eps=1e-5):
    m = x.mean(dim=axis, keepdim=True)
    v = x.var(dim=axis, keepdim=True, unbiased=False)
    return (x - m) / torch.sqrt(v + eps)
def _scatter_add(tgt, idx, src, axis=0):
    return tgt.clone().index_add_(axis, idx, src)
def _segment_sum(src, seg, n):
    out = torch.zeros((n,) + src.shape[1:], dtype=src.dtype)
    return out.index_add_(0, seg, src)
def _pad(x, pw):
    flat = tuple(v for pair in reversed(pw) for v in pair)
    return torch.nn.functional.pad(x, flat)

kernel_name = 'concat_heads__grouped_kv_mqa__grouped_kv_mqa__prompt'

def setup_inputs():

    _w = (lambda a: (lambda t: t.to(torch.bfloat16) if t.is_floating_point() else t)(torch.as_tensor(a)))
    def _A_setup():
        B, S, D, H = 1, 2048, 576, 32
        Dh = D // H
        return {
            "x": _w((lambda *s: torch.randn(*s, dtype=torch.bfloat16) * 0.05)(B, S, D)),
            "wq": _w((lambda *s: torch.randn(*s, dtype=torch.bfloat16) * 0.8)(D, H * Dh)),
            "wk": _w((lambda *s: torch.randn(*s, dtype=torch.bfloat16) * 0.8)(D, Dh)),
            "wv": _w((lambda *s: torch.randn(*s, dtype=torch.bfloat16) * 0.05)(D, Dh)),
            "wo": _w((lambda *s: torch.randn(*s, dtype=torch.bfloat16) * 0.05)(H * Dh, D)),
        }
    _A_in = _A_setup()

    def _B_setup():
        B, S, D, H = 1, 2048, 576, 32
        Dh = D // H
        return {
            "x": _w((lambda *s: torch.randn(*s, dtype=torch.bfloat16) * 0.05)(B, S, D)),
            "wq": _w((lambda *s: torch.randn(*s, dtype=torch.bfloat16) * 0.8)(D, H * Dh)),
            "wk": _w((lambda *s: torch.randn(*s, dtype=torch.bfloat16) * 0.8)(D, Dh)),
            "wv": _w((lambda *s: torch.randn(*s, dtype=torch.bfloat16) * 0.05)(D, Dh)),
            "wo": _w((lambda *s: torch.randn(*s, dtype=torch.bfloat16) * 0.05)(H * Dh, D)),
        }
    _B_in = _B_setup()

    return {
        "A_x": _A_in["x"],
        "A_wq": _A_in["wq"],
        "A_wk": _A_in["wk"],
        "A_wv": _A_in["wv"],
        "A_wo": _A_in["wo"],
        "B_x": _B_in["x"],
        "B_wq": _B_in["wq"],
        "B_wk": _B_in["wk"],
        "B_wv": _B_in["wv"],
        "B_wo": _B_in["wo"],
    }

def reference(A_x, A_wq, A_wk, A_wv, A_wo, B_x, B_wq, B_wk, B_wv, B_wo):
    def _A_ref(x, wq, wk, wv, wo):
        B, S, D = x.shape
        H = 32
        Dh = D // H
        q = (lambda x, *d: x.permute(*d))((x @ wq).reshape(B, S, H, Dh), 0, 2, 1, 3)
        k = x @ wk
        v = x @ wv
        scores = torch.einsum("bhqd,bkd->bhqk", q, k) * (Dh ** -0.5)
        p = _softmax(scores, axis=-1)
        o = torch.einsum("bhqk,bkd->bhqd", p, v)
        return (lambda x, *d: x.permute(*d))(o, 0, 2, 1, 3).reshape(B, S, H * Dh) @ wo

    def _B_ref(x, wq, wk, wv, wo):
        B, S, D = x.shape
        H = 32
        Dh = D // H
        q = (lambda x, *d: x.permute(*d))((x @ wq).reshape(B, S, H, Dh), 0, 2, 1, 3)
        k = x @ wk
        v = x @ wv
        scores = torch.einsum("bhqd,bkd->bhqk", q, k) * (Dh ** -0.5)
        p = _softmax(scores, axis=-1)
        o = torch.einsum("bhqk,bkd->bhqd", p, v)
        return (lambda x, *d: x.permute(*d))(o, 0, 2, 1, 3).reshape(B, S, H * Dh) @ wo

    a = _A_ref(A_x, A_wq, A_wk, A_wv, A_wo)
    b = _B_ref(B_x, B_wq, B_wk, B_wv, B_wo)
    return torch.concatenate([a, b], axis=-1)
```

```asm
; @launch grid=(256,1,1) block=(512,1,1) lds=163840
.amdgcn_target "amdgcn-amd-amdhsa--gfx950"
.text
.globl concat_heads__grouped_kv_mqa__grouped_kv_mqa__prompt_kernel
.p2align 8
.type concat_heads__grouped_kv_mqa__grouped_kv_mqa__prompt_kernel,@function
concat_heads__grouped_kv_mqa__grouped_kv_mqa__prompt_kernel:
    s_cmp_ge_u32 s2, 256
    s_cbranch_scc1 L_end
    s_load_dwordx16 s[16:31], s[0:1], 0
    s_load_dwordx8 s[32:39], s[0:1], 64
    s_load_dwordx2 s[40:41], s[0:1], 96
    s_getpc_b64 s[42:43]
L_pc:
    v_lshrrev_b32 v1, 6, v0
    v_and_b32 v0, 63, v0
    v_readfirstlane_b32 s3, v1
    v_lshlrev_b32 v1, 4, v0
    s_lshr_b32 s11, s2, 3
    s_and_b32 s4, s2, 1
    s_and_b32 s5, s11, 3
    s_lshr_b32 s6, s2, 5
    s_cmp_lg_u32 s3, 7
    s_cbranch_scc1 L_nopf
    s_cmp_ge_u32 s11, (L_codeend-concat_heads__grouped_kv_mqa__grouped_kv_mqa__prompt_kernel)/1024
    s_cbranch_scc1 L_nopf
    s_lshl_b32 s11, s11, 10
    s_sub_u32 s9, s42, L_pc-concat_heads__grouped_kv_mqa__grouped_kv_mqa__prompt_kernel
    s_subb_u32 s10, s43, 0
    s_add_u32 s9, s9, s11
    s_addc_u32 s10, s10, 0
    v_mov_b32 v7, s10
    v_add_co_u32 v6, vcc, s9, v1
    s_nop 1
    v_addc_co_u32 v7, vcc, 0, v7, vcc
    s_nop 0
    global_load_dwordx4 v[24:27], v[6:7], off
L_nopf:
    s_bfe_u32 s7, s2, 0x20001
    s_lshl_b32 s7, s7, 3
    s_add_u32 s7, s7, s6
    s_and_b32 s8, s3, 3
    s_and_b32 s76, s3, 1
    s_lshr_b32 s77, s8, 1
    v_lshrrev_b32 v8, 3, v0
    v_lshrrev_b32 v9, 4, v0
    s_lshl_b32 s9, s76, 2
    v_or_b32 v9, s9, v9
    v_and_b32 v10, 7, v0
    v_xor_b32 v9, v9, v10
    v_lshlrev_b32 v9, 4, v9
    v_mov_b32 v10, 0x480
    v_mad_u32_u24 v8, v8, v10, v9
    s_lshl_b32 s9, s8, 6
    v_add_u32 v9, s9, v0
    v_mul_u32_u24 v10, 0xab, v9
    v_lshrrev_b32 v10, 9, v10
    v_mul_u32_u24 v10, 12, v10
    v_lshlrev_b32 v9, 4, v9
    v_sub_u32 v9, v9, v10
    s_and_b32 s13, s5, 2
    s_lshl_b32 s13, s13, 1
    s_add_u32 s13, s13, s8
    s_lshl_b32 s14, s7, 3
    s_add_u32 s100, s14, s13
    s_mul_i32 s100, s100, 9216
    s_mul_i32 s79, s13, 9216
    s_add_u32 s79, s79, 90112
    s_lshl_b32 s9, s8, 10
    s_add_u32 s9, s9, 62464
    s_lshr_b32 s10, s5, 1
    s_movk_i32 s72, 3072
    s_movk_i32 s73, 2304
    s_cmp_lt_u32 s3, 4
    s_cselect_b64 vcc, -1, 0
    s_cselect_b32 s100, s100, 0
    s_cselect_b32 s79, s79, s9
    s_cselect_b32 s10, s5, s10
    s_cselect_b32 s72, 1024, s72
    s_cselect_b32 s73, 128, s73
    v_cndmask_b32 v9, v9, v8, vcc
    s_bitcmp1_b32 s10, 0
    s_cselect_b32 s83, 5, 0
    s_add_u32 s101, s83, s6
    s_cmp_ge_u32 s101, 9
    s_cselect_b32 s9, 9, 0
    s_sub_u32 s101, s101, s9
    s_mul_i32 s101, s101, s73
    s_mul_i32 s83, s83, s72
    s_mul_i32 s74, s72, 9
    s_mul_i32 s75, s73, 9
    s_waitcnt lgkmcnt(0)
    s_cmp_eq_u32 s4, 0
    s_cselect_b64 s[44:45], s[16:17], s[26:27]
    s_cselect_b64 s[20:21], s[20:21], s[30:31]
    s_cselect_b64 s[22:23], s[22:23], s[32:33]
    s_cselect_b64 s[48:49], s[18:19], s[28:29]
    s_cselect_b64 s[56:57], s[24:25], s[34:35]
    s_bitcmp0_b32 s5, 0
    s_cselect_b64 s[52:53], s[20:21], s[22:23]
    s_mov_b32 s46, 2359296
    s_movk_i32 s54, 20736
    s_cmp_lt_u32 s3, 4
    s_cselect_b64 s[52:53], s[44:45], s[52:53]
    s_cselect_b32 s54, s46, s54
    s_mov_b32 s55, 0x20000
    s_mov_b32 s47, 0x20000
    s_cmp_lt_u32 s3, 4
    s_cbranch_scc1 L_r1
    s_setprio 1
    s_cmp_eq_u32 s3, 7
    s_cbranch_scc1 L_late
L_r1:
    s_add_u32 m0, s79, s83
    s_add_u32 s12, s100, s101
    buffer_load_dwordx4 v9, s[52:55], s12 offen lds
    s_add_u32 s101, s101, s73
    s_cmp_eq_u32 s101, s75
    s_cselect_b32 s101, 0, s101
    s_add_u32 s83, s83, s72
    s_cmp_eq_u32 s83, s74
    s_cselect_b32 s83, 0, s83
    s_add_u32 m0, s79, s83
    s_add_u32 s12, s100, s101
    buffer_load_dwordx4 v9, s[52:55], s12 offen lds
    s_add_u32 s101, s101, s73
    s_cmp_eq_u32 s101, s75
    s_cselect_b32 s101, 0, s101
    s_add_u32 s83, s83, s72
    s_cmp_eq_u32 s83, s74
    s_cselect_b32 s83, 0, s83
    s_add_u32 m0, s79, s83
    s_add_u32 s12, s100, s101
    buffer_load_dwordx4 v9, s[52:55], s12 offen lds
    s_add_u32 s101, s101, s73
    s_cmp_eq_u32 s101, s75
    s_cselect_b32 s101, 0, s101
    s_add_u32 s83, s83, s72
    s_cmp_eq_u32 s83, s74
    s_cselect_b32 s83, 0, s83
    s_add_u32 m0, s79, s83
    s_add_u32 s12, s100, s101
    buffer_load_dwordx4 v9, s[52:55], s12 offen lds
    s_add_u32 s101, s101, s73
    s_cmp_eq_u32 s101, s75
    s_cselect_b32 s101, 0, s101
    s_add_u32 s83, s83, s72
    s_cmp_eq_u32 s83, s74
    s_cselect_b32 s83, 0, s83
    s_add_u32 m0, s79, s83
    s_add_u32 s12, s100, s101
    buffer_load_dwordx4 v9, s[52:55], s12 offen lds
    s_add_u32 s101, s101, s73
    s_cmp_eq_u32 s101, s75
    s_cselect_b32 s101, 0, s101
    s_add_u32 s83, s83, s72
    s_cmp_eq_u32 s83, s74
    s_cselect_b32 s83, 0, s83
    s_add_u32 m0, s79, s83
    s_add_u32 s12, s100, s101
    buffer_load_dwordx4 v9, s[52:55], s12 offen lds
    s_add_u32 s101, s101, s73
    s_cmp_eq_u32 s101, s75
    s_cselect_b32 s101, 0, s101
    s_add_u32 s83, s83, s72
    s_cmp_eq_u32 s83, s74
    s_cselect_b32 s83, 0, s83
    s_add_u32 m0, s79, s83
    s_add_u32 s12, s100, s101
    buffer_load_dwordx4 v9, s[52:55], s12 offen lds
    s_add_u32 s101, s101, s73
    s_cmp_eq_u32 s101, s75
    s_cselect_b32 s101, 0, s101
    s_add_u32 s83, s83, s72
    s_cmp_eq_u32 s83, s74
    s_cselect_b32 s83, 0, s83
    s_add_u32 m0, s79, s83
    s_add_u32 s12, s100, s101
    buffer_load_dwordx4 v9, s[52:55], s12 offen lds
    s_add_u32 s101, s101, s73
    s_cmp_eq_u32 s101, s75
    s_cselect_b32 s101, 0, s101
    s_add_u32 s83, s83, s72
    s_cmp_eq_u32 s83, s74
    s_cselect_b32 s83, 0, s83
    s_add_u32 m0, s79, s83
    s_add_u32 s12, s100, s101
    buffer_load_dwordx4 v9, s[52:55], s12 offen lds
    s_cmp_ge_u32 s3, 4
    s_cbranch_scc1 L_late
    s_add_u32 s9, s42, L_table-L_pc
    s_addc_u32 s10, s43, 0
    v_mov_b32 v7, s10
    v_add_co_u32 v6, vcc, s9, v1
    s_nop 1
    v_addc_co_u32 v7, vcc, 0, v7, vcc
    s_nop 0
    global_load_dwordx4 v[20:23], v[6:7], off
    s_mov_b32 s50, 663552
    s_mov_b32 s51, 0x20000
    s_lshl_b32 s9, s8, 6
    s_mul_i32 s10, s5, 288
    v_mov_b32 v16, 0x480
    v_add_u32 v13, s9, v0
    v_mul_u32_u24 v14, 0xe39, v13
    v_lshrrev_b32 v14, 16, v14
    v_mul_u32_u24 v15, 18, v14
    v_sub_u32 v13, v13, v15
    v_lshlrev_b32 v13, 4, v13
    v_bfe_u32 v15, v14, 3, 1
    v_bfe_u32 v17, v14, 2, 1
    v_and_b32 v14, 19, v14
    v_lshl_add_u32 v14, v15, 2, v14
    v_lshl_add_u32 v14, v17, 3, v14
    v_mad_u32_u24 v13, v14, v16, v13
    v_add_u32 v10, s10, v13
    s_add_u32 s9, s9, 192
    v_add_u32 v13, s9, v0
    v_mul_u32_u24 v14, 0xe39, v13
    v_lshrrev_b32 v14, 16, v14
    v_mul_u32_u24 v15, 18, v14
    v_sub_u32 v13, v13, v15
    v_lshlrev_b32 v13, 4, v13
    v_bfe_u32 v15, v14, 3, 1
    v_bfe_u32 v17, v14, 2, 1
    v_and_b32 v14, 19, v14
    v_lshl_add_u32 v14, v15, 2, v14
    v_lshl_add_u32 v14, v17, 3, v14
    v_mad_u32_u24 v13, v14, v16, v13
    v_add_u32 v11, s10, v13
    s_add_u32 s9, s9, 192
    v_add_u32 v13, s9, v0
    v_mul_u32_u24 v14, 0xe39, v13
    v_lshrrev_b32 v14, 16, v14
    v_mul_u32_u24 v15, 18, v14
    v_sub_u32 v13, v13, v15
    v_lshlrev_b32 v13, 4, v13
    v_bfe_u32 v15, v14, 3, 1
    v_bfe_u32 v17, v14, 2, 1
    v_and_b32 v14, 19, v14
    v_lshl_add_u32 v14, v15, 2, v14
    v_lshl_add_u32 v14, v17, 3, v14
    v_mad_u32_u24 v13, v14, v16, v13
    v_add_u32 v12, s10, v13
    s_lshl_b32 s72, s8, 10
    s_mul_i32 s74, s6, 73728
    s_cmp_lt_u32 s8, 3
    s_cselect_b64 vcc, -1, 0
    s_mov_b32 s58, 663552
    s_mov_b32 s59, 0x20000
    s_mul_i32 s9, s4, 4194304
    s_add_u32 s60, s40, s9
    s_addc_u32 s61, s41, 0
    s_mov_b32 s62, 3211264
    s_mov_b32 s63, 0x20000
    s_mov_b32 s64, s36
    s_mov_b32 s65, s37
    s_mov_b32 s66, 4718592
    s_mov_b32 s67, 0x20000
    s_mov_b32 s68, s38
    s_mov_b32 s69, s39
    s_mov_b32 s70, 256
    s_mov_b32 s71, 0x20000
    v_lshrrev_b32 v16, 4, v0
    v_bfe_u32 v14, v0, 1, 3
    v_xor_b32 v13, v16, v14
    v_lshlrev_b32 v13, 4, v13
    v_and_b32 v14, 7, v0
    v_lshl_add_u32 v13, v14, 7, v13
    v_bfe_u32 v14, v0, 3, 1
    v_mul_u32_u24 v14, 0x2400, v14
    s_mul_i32 s9, s76, 36864
    s_add_u32 s9, s9, 90112
    v_add3_u32 v8, v14, v13, s9
    v_xor_b32 v9, 64, v8
    v_bfe_u32 v15, v0, 2, 3
    v_lshrrev_b32 v14, 5, v0
    v_lshl_add_u32 v15, v14, 4, v15
    v_mul_u32_u24 v15, 0x120, v15
    s_mul_i32 s9, s77, 144
    v_add_u32 v15, s9, v15
    v_and_b32 v13, 3, v0
    v_lshl_add_u32 v6, v13, 3, v15
    v_and_b32 v13, 1, v0
    v_mul_u32_u24 v13, 72, v13
    v_bfe_u32 v14, v0, 1, 1
    v_lshl_add_u32 v13, v14, 4, v13
    v_add3_u32 v7, v13, v15, 48
    v_mov_b32 v2, 0xdddddddd
    v_add_u32 v3, 12288, v1
    v_lshlrev_b32 v4, 2, v0
    v_add_u32 v4, 14336, v4
    v_mov_b32 v110, 0
    v_mov_b32 v111, 0
    v_mov_b32 v19, 10240
    s_mov_b32 s82, 1
    s_mul_i32 s78, s7, 73728
    s_add_u32 s78, s78, 851968
    s_mul_i32 s25, s5, 18432
    s_add_u32 s25, s25, s78
    s_add_u32 s27, s25, 8192
    s_add_u32 s28, s25, 16384
    s_lshl_b32 s23, s82, 13
    s_lshl_b32 s24, s82, 10
    s_add_u32 s9, s8, 0
    s_mul_i32 s10, s9, 7282
    s_lshr_b32 s10, s10, 16
    s_mul_i32 s11, s10, 9
    s_sub_u32 s11, s9, s11
    s_add_u32 s10, s10, 1
    s_lshl_b32 s9, s11, 10
    s_add_u32 s9, s9, s23
    s_add_u32 s12, s24, 16384
    s_lshl_b32 s30, s10, 14
    s_add_u32 s30, s30, s9
    s_lshl_b32 s16, s10, 11
    s_add_u32 s16, s16, s24
    s_add_u32 s16, s16, 65536
    s_cmp_eq_u32 s11, 8
    s_cselect_b32 s9, s12, s9
    s_cselect_b32 s30, s16, s30
    s_add_u32 s30, s30, 12288
    s_add_u32 s10, s10, s5
    s_and_b32 s10, s10, 3
    s_mul_i32 s10, s10, 18432
    s_add_u32 s9, s9, s10
    s_add_u32 s16, s9, s78
    s_add_u32 s9, s8, 4
    s_mul_i32 s10, s9, 7282
    s_lshr_b32 s10, s10, 16
    s_mul_i32 s11, s10, 9
    s_sub_u32 s11, s9, s11
    s_add_u32 s10, s10, 1
    s_lshl_b32 s9, s11, 10
    s_add_u32 s9, s9, s23
    s_add_u32 s12, s24, 16384
    s_lshl_b32 s31, s10, 14
    s_add_u32 s31, s31, s9
    s_lshl_b32 s17, s10, 11
    s_add_u32 s17, s17, s24
    s_add_u32 s17, s17, 65536
    s_cmp_eq_u32 s11, 8
    s_cselect_b32 s9, s12, s9
    s_cselect_b32 s31, s17, s31
    s_add_u32 s31, s31, 12288
    s_add_u32 s10, s10, s5
    s_and_b32 s10, s10, 3
    s_mul_i32 s10, s10, 18432
    s_add_u32 s9, s9, s10
    s_add_u32 s17, s9, s78
    s_add_u32 s9, s8, 8
    s_mul_i32 s10, s9, 7282
    s_lshr_b32 s10, s10, 16
    s_mul_i32 s11, s10, 9
    s_sub_u32 s11, s9, s11
    s_add_u32 s10, s10, 1
    s_lshl_b32 s9, s11, 10
    s_add_u32 s9, s9, s23
    s_add_u32 s12, s24, 16384
    s_lshl_b32 s32, s10, 14
    s_add_u32 s32, s32, s9
    s_lshl_b32 s18, s10, 11
    s_add_u32 s18, s18, s24
    s_add_u32 s18, s18, 65536
    s_cmp_eq_u32 s11, 8
    s_cselect_b32 s9, s12, s9
    s_cselect_b32 s32, s18, s32
    s_add_u32 s32, s32, 12288
    s_add_u32 s10, s10, s5
    s_and_b32 s10, s10, 3
    s_mul_i32 s10, s10, 18432
    s_add_u32 s9, s9, s10
    s_add_u32 s18, s9, s78
    s_add_u32 s9, s8, 12
    s_mul_i32 s10, s9, 7282
    s_lshr_b32 s10, s10, 16
    s_mul_i32 s11, s10, 9
    s_sub_u32 s11, s9, s11
    s_add_u32 s10, s10, 1
    s_lshl_b32 s9, s11, 10
    s_add_u32 s9, s9, s23
    s_add_u32 s12, s24, 16384
    s_lshl_b32 s33, s10, 14
    s_add_u32 s33, s33, s9
    s_lshl_b32 s19, s10, 11
    s_add_u32 s19, s19, s24
    s_add_u32 s19, s19, 65536
    s_cmp_eq_u32 s11, 8
    s_cselect_b32 s9, s12, s9
    s_cselect_b32 s33, s19, s33
    s_add_u32 s33, s33, 12288
    s_add_u32 s10, s10, s5
    s_and_b32 s10, s10, 3
    s_mul_i32 s10, s10, 18432
    s_add_u32 s9, s9, s10
    s_add_u32 s19, s9, s78
    s_add_u32 s9, s8, 16
    s_mul_i32 s10, s9, 7282
    s_lshr_b32 s10, s10, 16
    s_mul_i32 s11, s10, 9
    s_sub_u32 s11, s9, s11
    s_add_u32 s10, s10, 1
    s_lshl_b32 s9, s11, 10
    s_add_u32 s9, s9, s23
    s_add_u32 s12, s24, 16384
    s_lshl_b32 s34, s10, 14
    s_add_u32 s34, s34, s9
    s_lshl_b32 s20, s10, 11
    s_add_u32 s20, s20, s24
    s_add_u32 s20, s20, 65536
    s_cmp_eq_u32 s11, 8
    s_cselect_b32 s9, s12, s9
    s_cselect_b32 s34, s20, s34
    s_add_u32 s34, s34, 12288
    s_add_u32 s10, s10, s5
    s_and_b32 s10, s10, 3
    s_mul_i32 s10, s10, 18432
    s_add_u32 s9, s9, s10
    s_add_u32 s20, s9, s78
    s_add_u32 s9, s8, 20
    s_mul_i32 s10, s9, 7282
    s_lshr_b32 s10, s10, 16
    s_mul_i32 s11, s10, 9
    s_sub_u32 s11, s9, s11
    s_add_u32 s10, s10, 1
    s_lshl_b32 s9, s11, 10
    s_add_u32 s9, s9, s23
    s_add_u32 s12, s24, 16384
    s_lshl_b32 s35, s10, 14
    s_add_u32 s35, s35, s9
    s_lshl_b32 s21, s10, 11
    s_add_u32 s21, s21, s24
    s_add_u32 s21, s21, 65536
    s_cmp_eq_u32 s11, 8
    s_cselect_b32 s9, s12, s9
    s_cselect_b32 s35, s21, s35
    s_add_u32 s35, s35, 12288
    s_add_u32 s10, s10, s5
    s_and_b32 s10, s10, 3
    s_mul_i32 s10, s10, 18432
    s_add_u32 s9, s9, s10
    s_add_u32 s21, s9, s78
    s_add_u32 s9, s8, 24
    s_min_u32 s9, s9, 26
    s_mul_i32 s10, s9, 7282
    s_lshr_b32 s10, s10, 16
    s_mul_i32 s11, s10, 9
    s_sub_u32 s11, s9, s11
    s_add_u32 s10, s10, 1
    s_lshl_b32 s9, s11, 10
    s_add_u32 s9, s9, s23
    s_add_u32 s12, s24, 16384
    s_lshl_b32 s36, s10, 14
    s_add_u32 s36, s36, s9
    s_lshl_b32 s22, s10, 11
    s_add_u32 s22, s22, s24
    s_add_u32 s22, s22, 65536
    s_cmp_eq_u32 s11, 8
    s_cselect_b32 s9, s12, s9
    s_cselect_b32 s36, s22, s36
    s_add_u32 s36, s36, 12288
    s_add_u32 s10, s10, s5
    s_and_b32 s10, s10, 3
    s_mul_i32 s10, s10, 18432
    s_add_u32 s9, s9, s10
    s_add_u32 s22, s9, s78
    s_mul_i32 s9, s7, 147456
    s_mul_i32 s10, s4, 1152
    s_add_u32 s9, s9, s10
    s_mul_i32 s10, s5, 288
    s_add_u32 s9, s9, s10
    s_lshl_b32 s10, s8, 6
    s_add_u32 s10, s10, s9
    s_xor_b32 s11, s8, 0
    s_mul_i32 s11, s11, 36864
    s_add_u32 s37, s11, s10
    s_add_u32 s41, s11, s9
    s_add_u32 s41, s41, 256
    s_xor_b32 s11, s8, 1
    s_mul_i32 s11, s11, 36864
    s_add_u32 s38, s11, s10
    s_xor_b32 s11, s8, 2
    s_mul_i32 s11, s11, 36864
    s_add_u32 s39, s11, s10
    s_xor_b32 s11, s8, 3
    s_mul_i32 s11, s11, 36864
    s_add_u32 s40, s11, s10
    s_waitcnt vmcnt(1)
    s_barrier
    s_cbranch_vccz L_wq1
    s_add_u32 m0, s72, 0
    s_add_u32 s9, s74, 36864
    buffer_load_dwordx4 v10, s[48:51], s74 offen lds
    s_add_u32 m0, s72, 3072
    s_nop 0
    buffer_load_dwordx4 v11, s[48:51], s74 offen lds
    s_add_u32 m0, s72, 6144
    s_cmp_ge_u32 s9, 663552
    buffer_load_dwordx4 v12, s[48:51], s74 offen lds
    s_cselect_b32 s10, 663552, 0
    s_sub_u32 s74, s9, s10
L_wq1:
    s_cbranch_vccz L_wq2
    s_add_u32 m0, s72, 9216
    s_add_u32 s9, s74, 36864
    buffer_load_dwordx4 v10, s[48:51], s74 offen lds
    s_add_u32 m0, s72, 12288
    s_nop 0
    buffer_load_dwordx4 v11, s[48:51], s74 offen lds
    s_add_u32 m0, s72, 15360
    s_cmp_ge_u32 s9, 663552
    buffer_load_dwordx4 v12, s[48:51], s74 offen lds
    s_cselect_b32 s10, 663552, 0
    s_sub_u32 s74, s9, s10
L_wq2:
    s_cbranch_vccz L_wq3
    s_add_u32 m0, s72, 18432
    s_add_u32 s9, s74, 36864
    buffer_load_dwordx4 v10, s[48:51], s74 offen lds
    s_add_u32 m0, s72, 21504
    s_nop 0
    buffer_load_dwordx4 v11, s[48:51], s74 offen lds
    s_add_u32 m0, s72, 24576
    s_cmp_ge_u32 s9, 663552
    buffer_load_dwordx4 v12, s[48:51], s74 offen lds
    s_cselect_b32 s10, 663552, 0
    s_sub_u32 s74, s9, s10
L_wq3:
    s_cbranch_vccz L_wq4
    s_add_u32 m0, s72, 27648
    s_add_u32 s9, s74, 36864
    buffer_load_dwordx4 v10, s[48:51], s74 offen lds
    s_add_u32 m0, s72, 30720
    s_nop 0
    buffer_load_dwordx4 v11, s[48:51], s74 offen lds
    s_add_u32 m0, s72, 33792
    s_cmp_ge_u32 s9, 663552
    buffer_load_dwordx4 v12, s[48:51], s74 offen lds
    s_cselect_b32 s10, 663552, 0
    s_sub_u32 s74, s9, s10
L_wq4:
    s_cmp_eq_u32 s3, 3
    s_cbranch_scc0 L_e4
    s_waitcnt vmcnt(0)
L_e4:
    s_waitcnt vmcnt(6)
    v_mov_b32 v5, v20
    v_mov_b32 v21, 0x3f803f80
    s_barrier
    ds_read_b128 v[112:115], v8 offset:0
    ds_read_b128 v[116:119], v8 offset:18432
    ds_read_b64_tr_b16 v[64:65], v6 offset:0
    ds_read_b64_tr_b16 v[66:67], v6 offset:2304
    ds_read_b64_tr_b16 v[68:69], v6 offset:32
    ds_read_b64_tr_b16 v[70:71], v6 offset:2336
    ds_read_b64_tr_b16 v[72:73], v7 offset:0
    ds_read_b64_tr_b16 v[74:75], v7 offset:2304
    ds_read_b64_tr_b16 v[76:77], v6 offset:72
    ds_read_b64_tr_b16 v[78:79], v6 offset:2376
    ds_read_b64_tr_b16 v[80:81], v6 offset:104
    ds_read_b64_tr_b16 v[82:83], v6 offset:2408
    s_waitcnt lgkmcnt(8)
    v_mfma_f32_16x16x32_bf16 v[24:27], v[64:67], v[112:115], 0
    ds_read_b64_tr_b16 v[84:85], v6 offset:9216
    ds_read_b128 v[120:123], v9 offset:0
    ds_read_b128 v[124:127], v9 offset:18432
    v_mfma_f32_16x16x32_bf16 v[28:31], v[64:67], v[116:119], 0
    ds_read_b64_tr_b16 v[86:87], v6 offset:11520
    ds_read_b128 v[128:131], v8 offset:1024
    ds_read_b128 v[132:135], v8 offset:19456
    s_waitcnt lgkmcnt(12)
    v_mfma_f32_16x16x32_bf16 v[32:35], v[68:71], v[112:115], 0
    ds_read_b64_tr_b16 v[88:89], v6 offset:9248
    ds_read_b128 v[136:139], v9 offset:1024
    ds_read_b128 v[140:143], v9 offset:19456
    v_mfma_f32_16x16x32_bf16 v[36:39], v[68:71], v[116:119], 0
    ds_read_b64_tr_b16 v[90:91], v6 offset:11552
    ds_read_b128 v[144:147], v8 offset:2048
    ds_read_b128 v[148:151], v8 offset:20480
    s_waitcnt lgkmcnt(14)
    v_mfma_f32_16x16x32_bf16 v[40:43], v[72:75], v[112:115], 0
    ds_read_b64_tr_b16 v[92:93], v7 offset:9216
    ds_read_b128 v[152:155], v9 offset:2048
    ds_read_b128 v[156:159], v9 offset:20480
    v_mfma_f32_16x16x32_bf16 v[44:47], v[72:75], v[116:119], 0
    ds_read_b64_tr_b16 v[94:95], v7 offset:11520
    ds_read_b128 v[160:163], v8 offset:3072
    ds_read_b128 v[164:167], v8 offset:21504
    s_waitcnt lgkmcnt(14)
    v_mfma_f32_16x16x32_bf16 v[48:51], v[76:79], v[112:115], 0
    ds_read_b64_tr_b16 v[96:97], v6 offset:9288
    ds_read_b128 v[168:171], v9 offset:3072
    ds_read_b128 v[172:175], v9 offset:21504
    v_mfma_f32_16x16x32_bf16 v[52:55], v[76:79], v[116:119], 0
    ds_read_b64_tr_b16 v[98:99], v6 offset:11592
    ds_read_b128 v[176:179], v8 offset:4096
    ds_read_b128 v[180:183], v8 offset:22528
    s_waitcnt lgkmcnt(14)
    v_mfma_f32_16x16x32_bf16 v[56:59], v[80:83], v[112:115], 0
    ds_read_b64_tr_b16 v[100:101], v6 offset:9320
    ds_read_b128 v[184:187], v9 offset:4096
    ds_read_b128 v[188:191], v9 offset:22528
    v_mfma_f32_16x16x32_bf16 v[60:63], v[80:83], v[116:119], 0
    ds_read_b64_tr_b16 v[102:103], v6 offset:11624
    ds_read_b128 v[192:195], v8 offset:5120
    ds_read_b128 v[196:199], v8 offset:23552
    s_waitcnt vmcnt(0)
    s_barrier
    s_waitcnt lgkmcnt(14)
    v_mfma_f32_16x16x32_bf16 v[24:27], v[84:87], v[120:123], v[24:27]
    ds_read_b64_tr_b16 v[64:65], v6 offset:18432
    ds_read_b128 v[200:203], v9 offset:5120
    ds_read_b128 v[204:207], v9 offset:23552
    v_mfma_f32_16x16x32_bf16 v[28:31], v[84:87], v[124:127], v[28:31]
    ds_read_b64_tr_b16 v[66:67], v6 offset:20736
    ds_read_b128 v[208:211], v8 offset:6144
    ds_read_b128 v[212:215], v8 offset:24576
    s_waitcnt lgkmcnt(14)
    v_mfma_f32_16x16x32_bf16 v[32:35], v[88:91], v[120:123], v[32:35]
    ds_read_b64_tr_b16 v[68:69], v6 offset:18464
    ds_read_b128 v[216:219], v9 offset:6144
    ds_read_b128 v[220:223], v9 offset:24576
    v_mfma_f32_16x16x32_bf16 v[36:39], v[88:91], v[124:127], v[36:39]
    ds_read_b64_tr_b16 v[70:71], v6 offset:20768
    ds_read_b128 v[224:227], v8 offset:7168
    ds_read_b128 v[228:231], v8 offset:25600
    s_waitcnt lgkmcnt(14)
    v_mfma_f32_16x16x32_bf16 v[40:43], v[92:95], v[120:123], v[40:43]
    ds_read_b64_tr_b16 v[72:73], v7 offset:18432
    ds_read_b128 v[232:235], v9 offset:7168
    ds_read_b128 v[236:239], v9 offset:25600
    v_mfma_f32_16x16x32_bf16 v[44:47], v[92:95], v[124:127], v[44:47]
    ds_read_b64_tr_b16 v[74:75], v7 offset:20736
    ds_read_b128 v[240:243], v8 offset:8192
    ds_read_b128 v[244:247], v8 offset:26624
    s_waitcnt lgkmcnt(14)
    v_mfma_f32_16x16x32_bf16 v[48:51], v[96:99], v[120:123], v[48:51]
    ds_read_b64_tr_b16 v[76:77], v6 offset:18504
    ds_read_b128 v[248:251], v9 offset:8192
    ds_read_b128 v[252:255], v9 offset:26624
    v_mfma_f32_16x16x32_bf16 v[52:55], v[96:99], v[124:127], v[52:55]
    ds_read_b64_tr_b16 v[78:79], v6 offset:20808
    s_waitcnt lgkmcnt(14)
    v_mfma_f32_16x16x32_bf16 v[56:59], v[100:103], v[120:123], v[56:59]
    ds_read_b64_tr_b16 v[80:81], v6 offset:18536
    v_mfma_f32_16x16x32_bf16 v[60:63], v[100:103], v[124:127], v[60:63]
    ds_read_b64_tr_b16 v[82:83], v6 offset:20840
    s_waitcnt lgkmcnt(14)
    v_mfma_f32_16x16x32_bf16 v[24:27], v[64:67], v[128:131], v[24:27]
    ds_read_b64_tr_b16 v[84:85], v6 offset:27648
    v_mfma_f32_16x16x32_bf16 v[28:31], v[64:67], v[132:135], v[28:31]
    ds_read_b64_tr_b16 v[86:87], v6 offset:29952
    s_waitcnt lgkmcnt(14)
    v_mfma_f32_16x16x32_bf16 v[32:35], v[68:71], v[128:131], v[32:35]
    ds_read_b64_tr_b16 v[88:89], v6 offset:27680
    v_mfma_f32_16x16x32_bf16 v[36:39], v[68:71], v[132:135], v[36:39]
    ds_read_b64_tr_b16 v[90:91], v6 offset:29984
    s_waitcnt lgkmcnt(12)
    v_mfma_f32_16x16x32_bf16 v[40:43], v[72:75], v[128:131], v[40:43]
    ds_read_b64_tr_b16 v[92:93], v7 offset:27648
    v_mfma_f32_16x16x32_bf16 v[44:47], v[72:75], v[132:135], v[44:47]
    ds_read_b64_tr_b16 v[94:95], v7 offset:29952
    s_waitcnt lgkmcnt(8)
    v_mfma_f32_16x16x32_bf16 v[48:51], v[76:79], v[128:131], v[48:51]
    ds_read_b64_tr_b16 v[96:97], v6 offset:27720
    v_mfma_f32_16x16x32_bf16 v[52:55], v[76:79], v[132:135], v[52:55]
    ds_read_b64_tr_b16 v[98:99], v6 offset:30024
    s_waitcnt lgkmcnt(8)
    v_mfma_f32_16x16x32_bf16 v[56:59], v[80:83], v[128:131], v[56:59]
    ds_read_b64_tr_b16 v[100:101], v6 offset:27752
    v_mfma_f32_16x16x32_bf16 v[60:63], v[80:83], v[132:135], v[60:63]
    ds_read_b64_tr_b16 v[102:103], v6 offset:30056
    s_barrier
    s_waitcnt lgkmcnt(8)
    v_mfma_f32_16x16x32_bf16 v[24:27], v[84:87], v[136:139], v[24:27]
    ds_read_b64_tr_b16 v[64:65], v6 offset:36864
    v_mfma_f32_16x16x32_bf16 v[28:31], v[84:87], v[140:143], v[28:31]
    ds_read_b64_tr_b16 v[66:67], v6 offset:39168
    s_waitcnt lgkmcnt(8)
    v_mfma_f32_16x16x32_bf16 v[32:35], v[88:91], v[136:139], v[32:35]
    ds_read_b64_tr_b16 v[68:69], v6 offset:36896
    v_mfma_f32_16x16x32_bf16 v[36:39], v[88:91], v[140:143], v[36:39]
    ds_read_b64_tr_b16 v[70:71], v6 offset:39200
    s_waitcnt lgkmcnt(8)
    v_mfma_f32_16x16x32_bf16 v[40:43], v[92:95], v[136:139], v[40:43]
    ds_read_b64_tr_b16 v[72:73], v7 offset:36864
    v_mfma_f32_16x16x32_bf16 v[44:47], v[92:95], v[140:143], v[44:47]
    ds_read_b64_tr_b16 v[74:75], v7 offset:39168
    s_waitcnt lgkmcnt(8)
    v_mfma_f32_16x16x32_bf16 v[48:51], v[96:99], v[136:139], v[48:51]
    ds_read_b64_tr_b16 v[76:77], v6 offset:36936
    v_mfma_f32_16x16x32_bf16 v[52:55], v[96:99], v[140:143], v[52:55]
    ds_read_b64_tr_b16 v[78:79], v6 offset:39240
    s_waitcnt lgkmcnt(8)
    v_mfma_f32_16x16x32_bf16 v[56:59], v[100:103], v[136:139], v[56:59]
    ds_read_b64_tr_b16 v[80:81], v6 offset:36968
    v_mfma_f32_16x16x32_bf16 v[60:63], v[100:103], v[140:143], v[60:63]
    ds_read_b64_tr_b16 v[82:83], v6 offset:39272
    s_waitcnt lgkmcnt(8)
    v_mfma_f32_16x16x32_bf16 v[24:27], v[64:67], v[144:147], v[24:27]
    ds_read_b64_tr_b16 v[84:85], v6 offset:46080
    v_mfma_f32_16x16x32_bf16 v[28:31], v[64:67], v[148:151], v[28:31]
    ds_read_b64_tr_b16 v[86:87], v6 offset:48384
    s_waitcnt lgkmcnt(8)
    v_mfma_f32_16x16x32_bf16 v[32:35], v[68:71], v[144:147], v[32:35]
    ds_read_b64_tr_b16 v[88:89], v6 offset:46112
    v_mfma_f32_16x16x32_bf16 v[36:39], v[68:71], v[148:151], v[36:39]
    ds_read_b64_tr_b16 v[90:91], v6 offset:48416
    s_waitcnt lgkmcnt(8)
    v_mfma_f32_16x16x32_bf16 v[40:43], v[72:75], v[144:147], v[40:43]
    ds_read_b64_tr_b16 v[92:93], v7 offset:46080
    v_mfma_f32_16x16x32_bf16 v[44:47], v[72:75], v[148:151], v[44:47]
    ds_read_b64_tr_b16 v[94:95], v7 offset:48384
    s_waitcnt lgkmcnt(8)
    v_mfma_f32_16x16x32_bf16 v[48:51], v[76:79], v[144:147], v[48:51]
    ds_read_b64_tr_b16 v[96:97], v6 offset:46152
    v_mfma_f32_16x16x32_bf16 v[52:55], v[76:79], v[148:151], v[52:55]
    ds_read_b64_tr_b16 v[98:99], v6 offset:48456
    s_waitcnt lgkmcnt(8)
    v_mfma_f32_16x16x32_bf16 v[56:59], v[80:83], v[144:147], v[56:59]
    ds_read_b64_tr_b16 v[100:101], v6 offset:46184
    v_mfma_f32_16x16x32_bf16 v[60:63], v[80:83], v[148:151], v[60:63]
    ds_read_b64_tr_b16 v[102:103], v6 offset:48488
    s_barrier
    s_waitcnt lgkmcnt(8)
    v_mfma_f32_16x16x32_bf16 v[24:27], v[84:87], v[152:155], v[24:27]
    ds_read_b64_tr_b16 v[64:65], v6 offset:62464
    v_mfma_f32_16x16x32_bf16 v[28:31], v[84:87], v[156:159], v[28:31]
    ds_read_b64_tr_b16 v[66:67], v6 offset:64768
    s_waitcnt lgkmcnt(8)
    v_mfma_f32_16x16x32_bf16 v[32:35], v[88:91], v[152:155], v[32:35]
    ds_read_b64_tr_b16 v[68:69], v6 offset:62496
    v_mfma_f32_16x16x32_bf16 v[36:39], v[88:91], v[156:159], v[36:39]
    ds_read_b64_tr_b16 v[70:71], v6 offset:64800
    s_waitcnt lgkmcnt(8)
    v_mfma_f32_16x16x32_bf16 v[40:43], v[92:95], v[152:155], v[40:43]
    ds_read_b64_tr_b16 v[72:73], v7 offset:62464
    v_mfma_f32_16x16x32_bf16 v[44:47], v[92:95], v[156:159], v[44:47]
    ds_read_b64_tr_b16 v[74:75], v7 offset:64768
    s_waitcnt lgkmcnt(8)
    v_mfma_f32_16x16x32_bf16 v[48:51], v[96:99], v[152:155], v[48:51]
    ds_read_b64_tr_b16 v[76:77], v6 offset:62536
    v_mfma_f32_16x16x32_bf16 v[52:55], v[96:99], v[156:159], v[52:55]
    ds_read_b64_tr_b16 v[78:79], v6 offset:64840
    s_waitcnt lgkmcnt(8)
    v_mfma_f32_16x16x32_bf16 v[56:59], v[100:103], v[152:155], v[56:59]
    ds_read_b64_tr_b16 v[80:81], v6 offset:62568
    v_mfma_f32_16x16x32_bf16 v[60:63], v[100:103], v[156:159], v[60:63]
    ds_read_b64_tr_b16 v[82:83], v6 offset:64872
    v_add_u32 v6, 71680, v6
    v_add_u32 v7, 71680, v7
    s_waitcnt lgkmcnt(8)
    v_mfma_f32_16x16x32_bf16 v[24:27], v[64:67], v[160:163], v[24:27]
    ds_read_b64_tr_b16 v[84:85], v6 offset:0
    v_mfma_f32_16x16x32_bf16 v[28:31], v[64:67], v[164:167], v[28:31]
    ds_read_b64_tr_b16 v[86:87], v6 offset:2304
    s_waitcnt lgkmcnt(8)
    v_mfma_f32_16x16x32_bf16 v[32:35], v[68:71], v[160:163], v[32:35]
    ds_read_b64_tr_b16 v[88:89], v6 offset:32
    v_mfma_f32_16x16x32_bf16 v[36:39], v[68:71], v[164:167], v[36:39]
    ds_read_b64_tr_b16 v[90:91], v6 offset:2336
    s_waitcnt lgkmcnt(8)
    v_mfma_f32_16x16x32_bf16 v[40:43], v[72:75], v[160:163], v[40:43]
    ds_read_b64_tr_b16 v[92:93], v7 offset:0
    v_mfma_f32_16x16x32_bf16 v[44:47], v[72:75], v[164:167], v[44:47]
    ds_read_b64_tr_b16 v[94:95], v7 offset:2304
    s_waitcnt lgkmcnt(8)
    v_mfma_f32_16x16x32_bf16 v[48:51], v[76:79], v[160:163], v[48:51]
    ds_read_b64_tr_b16 v[96:97], v6 offset:72
    v_mfma_f32_16x16x32_bf16 v[52:55], v[76:79], v[164:167], v[52:55]
    ds_read_b64_tr_b16 v[98:99], v6 offset:2376
    s_waitcnt lgkmcnt(8)
    v_mfma_f32_16x16x32_bf16 v[56:59], v[80:83], v[160:163], v[56:59]
    ds_read_b64_tr_b16 v[100:101], v6 offset:104
    v_mfma_f32_16x16x32_bf16 v[60:63], v[80:83], v[164:167], v[60:63]
    ds_read_b64_tr_b16 v[102:103], v6 offset:2408
    s_barrier
    s_waitcnt lgkmcnt(8)
    v_mfma_f32_16x16x32_bf16 v[24:27], v[84:87], v[168:171], v[24:27]
    ds_read_b64_tr_b16 v[64:65], v6 offset:9216
    v_mfma_f32_16x16x32_bf16 v[28:31], v[84:87], v[172:175], v[28:31]
    ds_read_b64_tr_b16 v[66:67], v6 offset:11520
    s_waitcnt lgkmcnt(8)
    v_mfma_f32_16x16x32_bf16 v[32:35], v[88:91], v[168:171], v[32:35]
    ds_read_b64_tr_b16 v[68:69], v6 offset:9248
    v_mfma_f32_16x16x32_bf16 v[36:39], v[88:91], v[172:175], v[36:39]
    ds_read_b64_tr_b16 v[70:71], v6 offset:11552
    s_waitcnt lgkmcnt(8)
    v_mfma_f32_16x16x32_bf16 v[40:43], v[92:95], v[168:171], v[40:43]
    ds_read_b64_tr_b16 v[72:73], v7 offset:9216
    v_mfma_f32_16x16x32_bf16 v[44:47], v[92:95], v[172:175], v[44:47]
    ds_read_b64_tr_b16 v[74:75], v7 offset:11520
    s_waitcnt lgkmcnt(8)
    v_mfma_f32_16x16x32_bf16 v[48:51], v[96:99], v[168:171], v[48:51]
    ds_read_b64_tr_b16 v[76:77], v6 offset:9288
    v_mfma_f32_16x16x32_bf16 v[52:55], v[96:99], v[172:175], v[52:55]
    ds_read_b64_tr_b16 v[78:79], v6 offset:11592
    s_waitcnt lgkmcnt(8)
    v_mfma_f32_16x16x32_bf16 v[56:59], v[100:103], v[168:171], v[56:59]
    ds_read_b64_tr_b16 v[80:81], v6 offset:9320
    v_mfma_f32_16x16x32_bf16 v[60:63], v[100:103], v[172:175], v[60:63]
    ds_read_b64_tr_b16 v[82:83], v6 offset:11624
    s_waitcnt lgkmcnt(8)
    v_mfma_f32_16x16x32_bf16 v[24:27], v[64:67], v[176:179], v[24:27]
    ds_read_b64_tr_b16 v[84:85], v6 offset:18432
    v_mfma_f32_16x16x32_bf16 v[28:31], v[64:67], v[180:183], v[28:31]
    ds_read_b64_tr_b16 v[86:87], v6 offset:20736
    s_waitcnt lgkmcnt(8)
    v_mfma_f32_16x16x32_bf16 v[32:35], v[68:71], v[176:179], v[32:35]
    ds_read_b64_tr_b16 v[88:89], v6 offset:18464
    v_mfma_f32_16x16x32_bf16 v[36:39], v[68:71], v[180:183], v[36:39]
    ds_read_b64_tr_b16 v[90:91], v6 offset:20768
    s_waitcnt lgkmcnt(8)
    v_mfma_f32_16x16x32_bf16 v[40:43], v[72:75], v[176:179], v[40:43]
    ds_read_b64_tr_b16 v[92:93], v7 offset:18432
    v_mfma_f32_16x16x32_bf16 v[44:47], v[72:75], v[180:183], v[44:47]
    ds_read_b64_tr_b16 v[94:95], v7 offset:20736
    s_waitcnt lgkmcnt(8)
    v_mfma_f32_16x16x32_bf16 v[48:51], v[76:79], v[176:179], v[48:51]
    ds_read_b64_tr_b16 v[96:97], v6 offset:18504
    v_mfma_f32_16x16x32_bf16 v[52:55], v[76:79], v[180:183], v[52:55]
    ds_read_b64_tr_b16 v[98:99], v6 offset:20808
    s_waitcnt lgkmcnt(8)
    v_mfma_f32_16x16x32_bf16 v[56:59], v[80:83], v[176:179], v[56:59]
    ds_read_b64_tr_b16 v[100:101], v6 offset:18536
    v_mfma_f32_16x16x32_bf16 v[60:63], v[80:83], v[180:183], v[60:63]
    ds_read_b64_tr_b16 v[102:103], v6 offset:20840
    s_barrier
    s_waitcnt lgkmcnt(8)
    v_mfma_f32_16x16x32_bf16 v[24:27], v[84:87], v[184:187], v[24:27]
    ds_read_b64_tr_b16 v[64:65], v6 offset:27648
    v_mfma_f32_16x16x32_bf16 v[28:31], v[84:87], v[188:191], v[28:31]
    ds_read_b64_tr_b16 v[66:67], v6 offset:29952
    s_waitcnt lgkmcnt(8)
    v_mfma_f32_16x16x32_bf16 v[32:35], v[88:91], v[184:187], v[32:35]
    ds_read_b64_tr_b16 v[68:69], v6 offset:27680
    v_mfma_f32_16x16x32_bf16 v[36:39], v[88:91], v[188:191], v[36:39]
    ds_read_b64_tr_b16 v[70:71], v6 offset:29984
    s_waitcnt lgkmcnt(8)
    v_mfma_f32_16x16x32_bf16 v[40:43], v[92:95], v[184:187], v[40:43]
    ds_read_b64_tr_b16 v[72:73], v7 offset:27648
    v_mfma_f32_16x16x32_bf16 v[44:47], v[92:95], v[188:191], v[44:47]
    ds_read_b64_tr_b16 v[74:75], v7 offset:29952
    s_waitcnt lgkmcnt(8)
    v_mfma_f32_16x16x32_bf16 v[48:51], v[96:99], v[184:187], v[48:51]
    ds_read_b64_tr_b16 v[76:77], v6 offset:27720
    v_mfma_f32_16x16x32_bf16 v[52:55], v[96:99], v[188:191], v[52:55]
    ds_read_b64_tr_b16 v[78:79], v6 offset:30024
    s_waitcnt lgkmcnt(8)
    v_mfma_f32_16x16x32_bf16 v[56:59], v[100:103], v[184:187], v[56:59]
    ds_read_b64_tr_b16 v[80:81], v6 offset:27752
    v_mfma_f32_16x16x32_bf16 v[60:63], v[100:103], v[188:191], v[60:63]
    ds_read_b64_tr_b16 v[82:83], v6 offset:30056
    s_waitcnt lgkmcnt(8)
    v_mfma_f32_16x16x32_bf16 v[24:27], v[64:67], v[192:195], v[24:27]
    ds_read_b64_tr_b16 v[84:85], v6 offset:36864
    v_mfma_f32_16x16x32_bf16 v[28:31], v[64:67], v[196:199], v[28:31]
    ds_read_b64_tr_b16 v[86:87], v6 offset:39168
    s_waitcnt lgkmcnt(8)
    v_mfma_f32_16x16x32_bf16 v[32:35], v[68:71], v[192:195], v[32:35]
    ds_read_b64_tr_b16 v[88:89], v6 offset:36896
    v_mfma_f32_16x16x32_bf16 v[36:39], v[68:71], v[196:199], v[36:39]
    ds_read_b64_tr_b16 v[90:91], v6 offset:39200
    s_waitcnt lgkmcnt(8)
    v_mfma_f32_16x16x32_bf16 v[40:43], v[72:75], v[192:195], v[40:43]
    ds_read_b64_tr_b16 v[92:93], v7 offset:36864
    v_mfma_f32_16x16x32_bf16 v[44:47], v[72:75], v[196:199], v[44:47]
    ds_read_b64_tr_b16 v[94:95], v7 offset:39168
    s_waitcnt lgkmcnt(8)
    v_mfma_f32_16x16x32_bf16 v[48:51], v[76:79], v[192:195], v[48:51]
    ds_read_b64_tr_b16 v[96:97], v6 offset:36936
    v_mfma_f32_16x16x32_bf16 v[52:55], v[76:79], v[196:199], v[52:55]
    ds_read_b64_tr_b16 v[98:99], v6 offset:39240
    s_waitcnt lgkmcnt(8)
    v_mfma_f32_16x16x32_bf16 v[56:59], v[80:83], v[192:195], v[56:59]
    ds_read_b64_tr_b16 v[100:101], v6 offset:36968
    v_mfma_f32_16x16x32_bf16 v[60:63], v[80:83], v[196:199], v[60:63]
    ds_read_b64_tr_b16 v[102:103], v6 offset:39272
    s_barrier
    s_waitcnt lgkmcnt(8)
    v_mfma_f32_16x16x32_bf16 v[24:27], v[84:87], v[200:203], v[24:27]
    ds_read_b64_tr_b16 v[64:65], v6 offset:46080
    v_mfma_f32_16x16x32_bf16 v[28:31], v[84:87], v[204:207], v[28:31]
    ds_read_b64_tr_b16 v[66:67], v6 offset:48384
    s_waitcnt lgkmcnt(8)
    v_mfma_f32_16x16x32_bf16 v[32:35], v[88:91], v[200:203], v[32:35]
    ds_read_b64_tr_b16 v[68:69], v6 offset:46112
    v_mfma_f32_16x16x32_bf16 v[36:39], v[88:91], v[204:207], v[36:39]
    ds_read_b64_tr_b16 v[70:71], v6 offset:48416
    s_waitcnt lgkmcnt(8)
    v_mfma_f32_16x16x32_bf16 v[40:43], v[92:95], v[200:203], v[40:43]
    ds_read_b64_tr_b16 v[72:73], v7 offset:46080
    v_mfma_f32_16x16x32_bf16 v[44:47], v[92:95], v[204:207], v[44:47]
    ds_read_b64_tr_b16 v[74:75], v7 offset:48384
    s_waitcnt lgkmcnt(8)
    v_mfma_f32_16x16x32_bf16 v[48:51], v[96:99], v[200:203], v[48:51]
    ds_read_b64_tr_b16 v[76:77], v6 offset:46152
    v_mfma_f32_16x16x32_bf16 v[52:55], v[96:99], v[204:207], v[52:55]
    ds_read_b64_tr_b16 v[78:79], v6 offset:48456
    s_waitcnt lgkmcnt(8)
    v_mfma_f32_16x16x32_bf16 v[56:59], v[100:103], v[200:203], v[56:59]
    ds_read_b64_tr_b16 v[80:81], v6 offset:46184
    v_mfma_f32_16x16x32_bf16 v[60:63], v[100:103], v[204:207], v[60:63]
    ds_read_b64_tr_b16 v[82:83], v6 offset:48488
    s_waitcnt lgkmcnt(8)
    v_mfma_f32_16x16x32_bf16 v[24:27], v[64:67], v[208:211], v[24:27]
    ds_read_b64_tr_b16 v[84:85], v6 offset:55296
    v_mfma_f32_16x16x32_bf16 v[28:31], v[64:67], v[212:215], v[28:31]
    ds_read_b64_tr_b16 v[86:87], v6 offset:57600
    s_waitcnt lgkmcnt(8)
    v_mfma_f32_16x16x32_bf16 v[32:35], v[68:71], v[208:211], v[32:35]
    ds_read_b64_tr_b16 v[88:89], v6 offset:55328
    v_mfma_f32_16x16x32_bf16 v[36:39], v[68:71], v[212:215], v[36:39]
    ds_read_b64_tr_b16 v[90:91], v6 offset:57632
    s_waitcnt lgkmcnt(8)
    v_mfma_f32_16x16x32_bf16 v[40:43], v[72:75], v[208:211], v[40:43]
    ds_read_b64_tr_b16 v[92:93], v7 offset:55296
    v_mfma_f32_16x16x32_bf16 v[44:47], v[72:75], v[212:215], v[44:47]
    ds_read_b64_tr_b16 v[94:95], v7 offset:57600
    s_waitcnt lgkmcnt(8)
    v_mfma_f32_16x16x32_bf16 v[48:51], v[76:79], v[208:211], v[48:51]
    ds_read_b64_tr_b16 v[96:97], v6 offset:55368
    v_mfma_f32_16x16x32_bf16 v[52:55], v[76:79], v[212:215], v[52:55]
    ds_read_b64_tr_b16 v[98:99], v6 offset:57672
    s_waitcnt lgkmcnt(8)
    v_mfma_f32_16x16x32_bf16 v[56:59], v[80:83], v[208:211], v[56:59]
    ds_read_b64_tr_b16 v[100:101], v6 offset:55400
    v_mfma_f32_16x16x32_bf16 v[60:63], v[80:83], v[212:215], v[60:63]
    ds_read_b64_tr_b16 v[102:103], v6 offset:57704
    s_barrier
    v_add_u32 v6, 64512, v6
    v_add_u32 v7, 64512, v7
    s_waitcnt lgkmcnt(8)
    v_mfma_f32_16x16x32_bf16 v[24:27], v[84:87], v[216:219], v[24:27]
    ds_read_b64_tr_b16 v[64:65], v6 offset:0
    v_mfma_f32_16x16x32_bf16 v[28:31], v[84:87], v[220:223], v[28:31]
    ds_read_b64_tr_b16 v[66:67], v6 offset:2304
    s_waitcnt lgkmcnt(8)
    v_mfma_f32_16x16x32_bf16 v[32:35], v[88:91], v[216:219], v[32:35]
    ds_read_b64_tr_b16 v[68:69], v6 offset:32
    v_mfma_f32_16x16x32_bf16 v[36:39], v[88:91], v[220:223], v[36:39]
    ds_read_b64_tr_b16 v[70:71], v6 offset:2336
    s_waitcnt lgkmcnt(8)
    v_mfma_f32_16x16x32_bf16 v[40:43], v[92:95], v[216:219], v[40:43]
    ds_read_b64_tr_b16 v[72:73], v7 offset:0
    v_mfma_f32_16x16x32_bf16 v[44:47], v[92:95], v[220:223], v[44:47]
    ds_read_b64_tr_b16 v[74:75], v7 offset:2304
    s_waitcnt lgkmcnt(8)
    v_mfma_f32_16x16x32_bf16 v[48:51], v[96:99], v[216:219], v[48:51]
    ds_read_b64_tr_b16 v[76:77], v6 offset:72
    v_mfma_f32_16x16x32_bf16 v[52:55], v[96:99], v[220:223], v[52:55]
    ds_read_b64_tr_b16 v[78:79], v6 offset:2376
    s_waitcnt lgkmcnt(8)
    v_mfma_f32_16x16x32_bf16 v[56:59], v[100:103], v[216:219], v[56:59]
    ds_read_b64_tr_b16 v[80:81], v6 offset:104
    v_mfma_f32_16x16x32_bf16 v[60:63], v[100:103], v[220:223], v[60:63]
    ds_read_b64_tr_b16 v[82:83], v6 offset:2408
    s_waitcnt lgkmcnt(8)
    v_mfma_f32_16x16x32_bf16 v[24:27], v[64:67], v[224:227], v[24:27]
    ds_read_b64_tr_b16 v[84:85], v6 offset:9216
    v_mfma_f32_16x16x32_bf16 v[28:31], v[64:67], v[228:231], v[28:31]
    ds_read_b64_tr_b16 v[86:87], v6 offset:11520
    s_waitcnt lgkmcnt(8)
    v_mfma_f32_16x16x32_bf16 v[32:35], v[68:71], v[224:227], v[32:35]
    ds_read_b64_tr_b16 v[88:89], v6 offset:9248
    v_mfma_f32_16x16x32_bf16 v[36:39], v[68:71], v[228:231], v[36:39]
    ds_read_b64_tr_b16 v[90:91], v6 offset:11552
    s_waitcnt lgkmcnt(8)
    v_mfma_f32_16x16x32_bf16 v[40:43], v[72:75], v[224:227], v[40:43]
    ds_read_b64_tr_b16 v[92:93], v7 offset:9216
    v_mfma_f32_16x16x32_bf16 v[44:47], v[72:75], v[228:231], v[44:47]
    ds_read_b64_tr_b16 v[94:95], v7 offset:11520
    s_waitcnt lgkmcnt(8)
    v_mfma_f32_16x16x32_bf16 v[48:51], v[76:79], v[224:227], v[48:51]
    ds_read_b64_tr_b16 v[96:97], v6 offset:9288
    v_mfma_f32_16x16x32_bf16 v[52:55], v[76:79], v[228:231], v[52:55]
    ds_read_b64_tr_b16 v[98:99], v6 offset:11592
    s_waitcnt lgkmcnt(8)
    v_mfma_f32_16x16x32_bf16 v[56:59], v[80:83], v[224:227], v[56:59]
    ds_read_b64_tr_b16 v[100:101], v6 offset:9320
    v_mfma_f32_16x16x32_bf16 v[60:63], v[80:83], v[228:231], v[60:63]
    ds_read_b64_tr_b16 v[102:103], v6 offset:11624
    s_barrier
    s_waitcnt lgkmcnt(8)
    v_mfma_f32_16x16x32_bf16 v[24:27], v[84:87], v[232:235], v[24:27]
    ds_read_b64_tr_b16 v[64:65], v6 offset:18432
    v_mfma_f32_16x16x32_bf16 v[28:31], v[84:87], v[236:239], v[28:31]
    ds_read_b64_tr_b16 v[66:67], v6 offset:20736
    s_waitcnt lgkmcnt(8)
    v_mfma_f32_16x16x32_bf16 v[32:35], v[88:91], v[232:235], v[32:35]
    ds_read_b64_tr_b16 v[68:69], v6 offset:18464
    v_mfma_f32_16x16x32_bf16 v[36:39], v[88:91], v[236:239], v[36:39]
    ds_read_b64_tr_b16 v[70:71], v6 offset:20768
    s_waitcnt lgkmcnt(8)
    v_mfma_f32_16x16x32_bf16 v[40:43], v[92:95], v[232:235], v[40:43]
    ds_read_b64_tr_b16 v[72:73], v7 offset:18432
    v_mfma_f32_16x16x32_bf16 v[44:47], v[92:95], v[236:239], v[44:47]
    ds_read_b64_tr_b16 v[74:75], v7 offset:20736
    s_waitcnt lgkmcnt(8)
    v_mfma_f32_16x16x32_bf16 v[48:51], v[96:99], v[232:235], v[48:51]
    ds_read_b64_tr_b16 v[76:77], v6 offset:18504
    v_mfma_f32_16x16x32_bf16 v[52:55], v[96:99], v[236:239], v[52:55]
    ds_read_b64_tr_b16 v[78:79], v6 offset:20808
    s_waitcnt lgkmcnt(8)
    v_mfma_f32_16x16x32_bf16 v[56:59], v[100:103], v[232:235], v[56:59]
    ds_read_b64_tr_b16 v[80:81], v6 offset:18536
    v_mfma_f32_16x16x32_bf16 v[60:63], v[100:103], v[236:239], v[60:63]
    ds_read_b64_tr_b16 v[82:83], v6 offset:20840
    v_subrev_u32 v6, 90112, v6
    v_subrev_u32 v7, 90112, v7
    s_waitcnt lgkmcnt(8)
    v_mfma_f32_16x16x32_bf16 v[24:27], v[64:67], v[240:243], v[24:27]
    ds_read_b64_tr_b16 v[84:85], v6 offset:0
    v_mfma_f32_16x16x32_bf16 v[28:31], v[64:67], v[244:247], v[28:31]
    ds_read_b64_tr_b16 v[86:87], v6 offset:2304
    s_waitcnt lgkmcnt(8)
    v_mfma_f32_16x16x32_bf16 v[32:35], v[68:71], v[240:243], v[32:35]
    ds_read_b64_tr_b16 v[88:89], v6 offset:32
    v_mfma_f32_16x16x32_bf16 v[36:39], v[68:71], v[244:247], v[36:39]
    ds_read_b64_tr_b16 v[90:91], v6 offset:2336
    s_waitcnt lgkmcnt(8)
    v_mfma_f32_16x16x32_bf16 v[40:43], v[72:75], v[240:243], v[40:43]
    ds_read_b64_tr_b16 v[92:93], v7 offset:0
    v_mfma_f32_16x16x32_bf16 v[44:47], v[72:75], v[244:247], v[44:47]
    ds_read_b64_tr_b16 v[94:95], v7 offset:2304
    s_waitcnt lgkmcnt(8)
    v_mfma_f32_16x16x32_bf16 v[48:51], v[76:79], v[240:243], v[48:51]
    ds_read_b64_tr_b16 v[96:97], v6 offset:72
    v_mfma_f32_16x16x32_bf16 v[52:55], v[76:79], v[244:247], v[52:55]
    ds_read_b64_tr_b16 v[98:99], v6 offset:2376
    s_waitcnt lgkmcnt(8)
    v_mfma_f32_16x16x32_bf16 v[56:59], v[80:83], v[240:243], v[56:59]
    ds_read_b64_tr_b16 v[100:101], v6 offset:104
    v_mfma_f32_16x16x32_bf16 v[60:63], v[80:83], v[244:247], v[60:63]
    ds_read_b64_tr_b16 v[102:103], v6 offset:2408
    s_waitcnt lgkmcnt(8)
    v_mfma_f32_16x16x32_bf16 v[24:27], v[84:87], v[248:251], v[24:27]
    v_mfma_f32_16x16x32_bf16 v[28:31], v[84:87], v[252:255], v[28:31]
    s_waitcnt lgkmcnt(6)
    v_mfma_f32_16x16x32_bf16 v[32:35], v[88:91], v[248:251], v[32:35]
    v_mfma_f32_16x16x32_bf16 v[36:39], v[88:91], v[252:255], v[36:39]
    s_waitcnt lgkmcnt(4)
    v_mfma_f32_16x16x32_bf16 v[40:43], v[92:95], v[248:251], v[40:43]
    v_mfma_f32_16x16x32_bf16 v[44:47], v[92:95], v[252:255], v[44:47]
    s_waitcnt lgkmcnt(2)
    v_mfma_f32_16x16x32_bf16 v[48:51], v[96:99], v[248:251], v[48:51]
    v_mfma_f32_16x16x32_bf16 v[52:55], v[96:99], v[252:255], v[52:55]
    s_waitcnt lgkmcnt(0)
    v_mfma_f32_16x16x32_bf16 v[56:59], v[100:103], v[248:251], v[56:59]
    v_mfma_f32_16x16x32_bf16 v[60:63], v[100:103], v[252:255], v[60:63]
    v_mov_b32 v7, v19
    v_mov_b32 v19, 0x3f803f80
    s_mov_b32 s75, 7
    s_mov_b32 vcc_lo, 0
    s_mov_b32 vcc_hi, -1
    s_nop 2
    v_cvt_pk_bf16_f32 v8, v24, v25
    v_cvt_pk_bf16_f32 v10, v28, v29
    v_cvt_pk_bf16_f32 v9, v26, v27
    v_cvt_pk_bf16_f32 v11, v30, v31
    v_permlane16_swap_b32 v8, v10
    v_cvt_pk_bf16_f32 v16, v32, v33
    v_cvt_pk_bf16_f32 v13, v36, v37
    v_permlane16_swap_b32 v9, v11
    v_cvt_pk_bf16_f32 v12, v34, v35
    v_cvt_pk_bf16_f32 v14, v38, v39
    v_permlane16_swap_b32 v16, v13
    v_cvt_pk_bf16_f32 v15, v40, v41
    v_cvt_pk_bf16_f32 v155, v44, v45
    v_permlane16_swap_b32 v12, v14
    v_cvt_pk_bf16_f32 v108, v42, v43
    v_cvt_pk_bf16_f32 v107, v46, v47
    v_permlane16_swap_b32 v15, v155
    v_cvt_pk_bf16_f32 v148, v48, v49
    v_cvt_pk_bf16_f32 v150, v52, v53
    v_permlane16_swap_b32 v108, v107
    v_cvt_pk_bf16_f32 v149, v50, v51
    v_cvt_pk_bf16_f32 v151, v54, v55
    v_permlane16_swap_b32 v148, v150
    v_cvt_pk_bf16_f32 v156, v56, v57
    v_cvt_pk_bf16_f32 v153, v60, v61
    v_permlane16_swap_b32 v149, v151
    v_cvt_pk_bf16_f32 v152, v58, v59
    v_cvt_pk_bf16_f32 v154, v62, v63
    v_permlane16_swap_b32 v156, v153
    s_nop 0
    v_permlane16_swap_b32 v152, v154
    v_cndmask_b32 v16, v16, v108, vcc
    v_cndmask_b32 v156, v156, v107, vcc
    v_mfma_f32_32x32x8_bf16 v[176:191], v[110:111], v[110:111], 0
    v_mfma_f32_32x32x8_bf16 v[24:39], v[110:111], v[110:111], 0
    s_barrier
    ds_read_b32 v6, v7
    ds_read_b32 v18, v4 offset:0
    ds_read_b128 v[56:59], v3 offset:0
    ds_read_b128 v[60:63], v3 offset:1024
    ds_read_b128 v[64:67], v5 offset:0
    ds_read_b128 v[68:71], v5 offset:608
    v_dot2_f32_bf16 v17, v8, v8, 0
    v_dot2_f32_bf16 v108, v12, v12, 0
    v_dot2_f32_bf16 v157, v148, v148, 0
    v_dot2_f32_bf16 v107, v152, v152, 0
    v_dot2_f32_bf16 v17, v9, v9, v17
    v_dot2_f32_bf16 v108, v13, v13, v108
    v_dot2_f32_bf16 v157, v149, v149, v157
    v_dot2_f32_bf16 v107, v153, v153, v107
    v_dot2_f32_bf16 v17, v10, v10, v17
    v_dot2_f32_bf16 v108, v14, v14, v108
    v_dot2_f32_bf16 v157, v150, v150, v157
    v_dot2_f32_bf16 v107, v154, v154, v107
    v_dot2_f32_bf16 v17, v11, v11, v17
    v_dot2_f32_bf16 v108, v15, v15, v108
    v_dot2_f32_bf16 v157, v151, v151, v157
    v_dot2_f32_bf16 v107, v155, v155, v107
    s_nop 0
    v_permlane32_swap_b32 v17, v108
    s_nop 0
    v_permlane32_swap_b32 v157, v107
    v_add_f32 v17, v17, v108
    v_add_f32 v157, v157, v107
    v_dot2_f32_bf16 v17, v16, v16, v17
    v_dot2_f32_bf16 v157, v156, v156, v157
    s_nop 1
    v_sqrt_f32 v17, v17
    v_sqrt_f32 v157, v157
    v_mfma_f32_32x32x8_bf16 v[40:55], v[110:111], v[110:111], 0
    v_mfma_f32_32x32x8_bf16 v[160:175], v[110:111], v[110:111], 0
    v_mov_b32 v76, 0
    v_mov_b32 v77, 0
    v_mov_b32 v78, 0
    v_mov_b32 v79, 0
    s_setprio 1
    s_waitcnt lgkmcnt(0)
    v_mul_f32 v7, v6, v17
    v_mul_f32 v22, v6, v157
    v_mov_b32 v6, 0x42200000
    v_cmp_nle_f32 vcc, v7, v6
    v_cmp_nle_f32 s[42:43], v22, v6
    v_sub_f32 v7, 0, v7
    v_sub_f32 v22, 0, v22
    v_cvt_pk_bf16_f32 v17, v7, 0
    v_cvt_pk_bf16_f32 v157, v22, 0
    s_or_b64 vcc, vcc, s[42:43]
    s_cbranch_vccnz L_fallback
L_fbdone:
    s_nop 0
    v_mfma_f32_32x32x4_2b_bf16 v[80:111], v[18:19], v[16:17], 0 cbsz:1 abid:0
    s_lshl_b32 s9, s77, 12
    s_lshl_b32 s10, s76, 11
    s_add_u32 s11, s9, s10
    s_lshl_b32 s9, s76, 9
    s_lshl_b32 s10, s77, 7
    s_add_u32 s12, s9, s10
    v_mov_b32 v146, 10260
    s_mov_b32 s15, 8
    v_bfe_u32 v6, v0, 4, 1
    v_lshrrev_b32 v7, 5, v0
    v_and_b32 v22, 15, v0
    v_lshlrev_b32 v144, 10, v6
    v_lshl_add_u32 v144, v7, 9, v144
    v_lshl_add_u32 v144, v22, 4, v144
    v_add_u32 v144, s11, v144
    v_lshlrev_b32 v145, 8, v6
    v_lshl_add_u32 v145, v7, 6, v145
    v_lshl_add_u32 v145, v22, 2, v145
    v_mfma_f32_32x32x16_bf16 v[80:95], v[56:59], v[8:11], v[80:95]
    v_mfma_f32_32x32x16_bf16 v[96:111], v[56:59], v[12:15], v[96:111]
    v_add_u32 v145, s12, v145
    s_nop 9
    .p2align 6
L_main:
    v_exp_f32 v80, v80
    v_exp_f32 v81, v81
    v_smfmac_f32_32x32x32_bf16 v[176:191], v[76:79], v[136:143], v2
    ds_read_b128 v[72:75], v5 offset:1216
    v_exp_f32 v82, v82
    v_exp_f32 v83, v83
    v_exp_f32 v84, v84
    v_mfma_f32_32x32x4_2b_bf16 v[112:143], v[18:19], v[156:157], 0 cbsz:1 abid:0
    v_exp_f32 v85, v85
    v_exp_f32 v86, v86
    v_exp_f32 v87, v87
    v_exp_f32 v88, v88
    v_exp_f32 v89, v89
    v_exp_f32 v90, v90
    v_exp_f32 v91, v91
    v_exp_f32 v92, v92
    v_smfmac_f32_32x32x32_bf16 v[24:39], v[64:67], v[80:87], v2
    ds_read_b128 v[76:79], v5 offset:1824
    v_exp_f32 v93, v93
    v_exp_f32 v94, v94
    v_exp_f32 v95, v95
    v_exp_f32 v96, v96
    v_exp_f32 v97, v97
    v_smfmac_f32_32x32x32_bf16 v[24:39], v[68:71], v[88:95], v2
    v_exp_f32 v98, v98
    v_exp_f32 v99, v99
    v_exp_f32 v100, v100
    v_mfma_f32_32x32x16_bf16 v[112:127], v[56:59], v[148:151], v[112:127]
    v_exp_f32 v101, v101
    v_exp_f32 v102, v102
    v_exp_f32 v103, v103
    v_mfma_f32_32x32x16_bf16 v[128:143], v[56:59], v[152:155], v[128:143]
    v_exp_f32 v104, v104
    v_exp_f32 v105, v105
    v_exp_f32 v106, v106
    v_smfmac_f32_32x32x32_bf16 v[40:55], v[64:67], v[96:103], v2
    v_exp_f32 v107, v107
    v_exp_f32 v108, v108
    v_exp_f32 v109, v109
    v_exp_f32 v110, v110
    v_exp_f32 v111, v111
    v_exp_f32 v112, v112
    v_exp_f32 v113, v113
    v_smfmac_f32_32x32x32_bf16 v[40:55], v[68:71], v[104:111], v2
    v_exp_f32 v114, v114
    v_exp_f32 v115, v115
    v_exp_f32 v116, v116
    v_mfma_f32_32x32x4_2b_bf16 v[80:111], v[18:19], v[16:17], 0 cbsz:1 abid:1
    v_exp_f32 v117, v117
    v_exp_f32 v118, v118
    v_exp_f32 v119, v119
    v_exp_f32 v120, v120
    v_exp_f32 v121, v121
    v_exp_f32 v122, v122
    v_exp_f32 v123, v123
    v_exp_f32 v124, v124
    v_smfmac_f32_32x32x32_bf16 v[160:175], v[64:67], v[112:119], v2
    v_exp_f32 v125, v125
    v_exp_f32 v126, v126
    v_exp_f32 v127, v127
    v_exp_f32 v128, v128
    v_exp_f32 v129, v129
    v_smfmac_f32_32x32x32_bf16 v[160:175], v[68:71], v[120:127], v2
    ds_read_b128 v[56:59], v3 offset:4736
    v_exp_f32 v130, v130
    v_exp_f32 v131, v131
    v_exp_f32 v132, v132
    v_mfma_f32_32x32x16_bf16 v[80:95], v[60:63], v[8:11], v[80:95]
    ds_read_b32 v20, v4 offset:4736
    v_exp_f32 v133, v133
    v_exp_f32 v134, v134
    v_exp_f32 v135, v135
    v_mfma_f32_32x32x16_bf16 v[96:111], v[60:63], v[12:15], v[96:111]
    v_exp_f32 v136, v136
    v_exp_f32 v137, v137
    v_exp_f32 v138, v138
    v_smfmac_f32_32x32x32_bf16 v[176:191], v[64:67], v[128:135], v2
    s_waitcnt lgkmcnt(0)
    v_exp_f32 v139, v139
    v_exp_f32 v140, v140
    v_exp_f32 v141, v141
    v_exp_f32 v142, v142
    v_exp_f32 v143, v143
    v_exp_f32 v80, v80
    v_exp_f32 v81, v81
    v_smfmac_f32_32x32x32_bf16 v[176:191], v[68:71], v[136:143], v2
    ds_read_b128 v[64:67], v5 offset:4736
    v_exp_f32 v82, v82
    v_exp_f32 v83, v83
    v_exp_f32 v84, v84
    v_mfma_f32_32x32x4_2b_bf16 v[112:143], v[18:19], v[156:157], 0 cbsz:1 abid:1
    v_exp_f32 v85, v85
    v_exp_f32 v86, v86
    v_exp_f32 v87, v87
    v_exp_f32 v88, v88
    v_exp_f32 v89, v89
    v_exp_f32 v90, v90
    v_exp_f32 v91, v91
    v_exp_f32 v92, v92
    v_smfmac_f32_32x32x32_bf16 v[24:39], v[72:75], v[80:87], v2
    ds_read_b128 v[68:71], v5 offset:5344
    v_exp_f32 v93, v93
    v_exp_f32 v94, v94
    v_exp_f32 v95, v95
    v_exp_f32 v96, v96
    v_exp_f32 v97, v97
    v_smfmac_f32_32x32x32_bf16 v[24:39], v[76:79], v[88:95], v2
    v_exp_f32 v98, v98
    v_exp_f32 v99, v99
    v_exp_f32 v100, v100
    v_mfma_f32_32x32x16_bf16 v[112:127], v[60:63], v[148:151], v[112:127]
    v_exp_f32 v101, v101
    v_exp_f32 v102, v102
    v_exp_f32 v103, v103
    v_mfma_f32_32x32x16_bf16 v[128:143], v[60:63], v[152:155], v[128:143]
    v_exp_f32 v104, v104
    v_exp_f32 v105, v105
    v_exp_f32 v106, v106
    v_smfmac_f32_32x32x32_bf16 v[40:55], v[72:75], v[96:103], v2
    v_exp_f32 v107, v107
    v_exp_f32 v108, v108
    v_exp_f32 v109, v109
    v_exp_f32 v110, v110
    v_exp_f32 v111, v111
    v_exp_f32 v112, v112
    v_exp_f32 v113, v113
    v_smfmac_f32_32x32x32_bf16 v[40:55], v[76:79], v[104:111], v2
    v_exp_f32 v114, v114
    v_exp_f32 v115, v115
    v_exp_f32 v116, v116
    v_mfma_f32_32x32x4_2b_bf16 v[80:111], v[20:21], v[16:17], 0 cbsz:1 abid:0
    v_exp_f32 v117, v117
    v_exp_f32 v118, v118
    v_exp_f32 v119, v119
    v_exp_f32 v120, v120
    v_exp_f32 v121, v121
    v_exp_f32 v122, v122
    v_exp_f32 v123, v123
    v_exp_f32 v124, v124
    v_smfmac_f32_32x32x32_bf16 v[160:175], v[72:75], v[112:119], v2
    v_exp_f32 v125, v125
    v_exp_f32 v126, v126
    v_exp_f32 v127, v127
    v_exp_f32 v128, v128
    v_exp_f32 v129, v129
    v_smfmac_f32_32x32x32_bf16 v[160:175], v[76:79], v[120:127], v2
    ds_read_b128 v[60:63], v3 offset:5760
    v_exp_f32 v130, v130
    v_exp_f32 v131, v131
    v_exp_f32 v132, v132
    v_mfma_f32_32x32x16_bf16 v[80:95], v[56:59], v[8:11], v[80:95]
    v_exp_f32 v133, v133
    v_exp_f32 v134, v134
    v_exp_f32 v135, v135
    v_mfma_f32_32x32x16_bf16 v[96:111], v[56:59], v[12:15], v[96:111]
    v_exp_f32 v136, v136
    v_exp_f32 v137, v137
    v_exp_f32 v138, v138
    v_smfmac_f32_32x32x32_bf16 v[176:191], v[72:75], v[128:135], v2
    s_waitcnt lgkmcnt(0)
    v_exp_f32 v139, v139
    v_exp_f32 v140, v140
    v_exp_f32 v141, v141
    v_exp_f32 v142, v142
    v_exp_f32 v143, v143
    v_exp_f32 v80, v80
    v_exp_f32 v81, v81
    v_smfmac_f32_32x32x32_bf16 v[176:191], v[76:79], v[136:143], v2
    ds_read_b128 v[72:75], v5 offset:5952
    v_exp_f32 v82, v82
    v_exp_f32 v83, v83
    v_exp_f32 v84, v84
    v_mfma_f32_32x32x4_2b_bf16 v[112:143], v[20:21], v[156:157], 0 cbsz:1 abid:0
    v_exp_f32 v85, v85
    v_exp_f32 v86, v86
    v_exp_f32 v87, v87
    v_exp_f32 v88, v88
    v_exp_f32 v89, v89
    v_exp_f32 v90, v90
    v_exp_f32 v91, v91
    v_exp_f32 v92, v92
    v_smfmac_f32_32x32x32_bf16 v[24:39], v[64:67], v[80:87], v2
    ds_read_b128 v[76:79], v5 offset:6560
    v_exp_f32 v93, v93
    v_exp_f32 v94, v94
    v_exp_f32 v95, v95
    v_exp_f32 v96, v96
    v_exp_f32 v97, v97
    v_smfmac_f32_32x32x32_bf16 v[24:39], v[68:71], v[88:95], v2
    v_exp_f32 v98, v98
    v_exp_f32 v99, v99
    v_exp_f32 v100, v100
    v_mfma_f32_32x32x16_bf16 v[112:127], v[56:59], v[148:151], v[112:127]
    v_exp_f32 v101, v101
    v_exp_f32 v102, v102
    v_exp_f32 v103, v103
    v_mfma_f32_32x32x16_bf16 v[128:143], v[56:59], v[152:155], v[128:143]
    v_exp_f32 v104, v104
    v_exp_f32 v105, v105
    v_exp_f32 v106, v106
    v_smfmac_f32_32x32x32_bf16 v[40:55], v[64:67], v[96:103], v2
    v_exp_f32 v107, v107
    v_exp_f32 v108, v108
    v_exp_f32 v109, v109
    v_exp_f32 v110, v110
    v_exp_f32 v111, v111
    v_exp_f32 v112, v112
    v_exp_f32 v113, v113
    v_smfmac_f32_32x32x32_bf16 v[40:55], v[68:71], v[104:111], v2
    v_exp_f32 v114, v114
    v_exp_f32 v115, v115
    v_exp_f32 v116, v116
    v_mfma_f32_32x32x4_2b_bf16 v[80:111], v[20:21], v[16:17], 0 cbsz:1 abid:1
    v_exp_f32 v117, v117
    v_exp_f32 v118, v118
    v_exp_f32 v119, v119
    v_exp_f32 v120, v120
    v_exp_f32 v121, v121
    v_exp_f32 v122, v122
    v_exp_f32 v123, v123
    v_exp_f32 v124, v124
    v_smfmac_f32_32x32x32_bf16 v[160:175], v[64:67], v[112:119], v2
    v_exp_f32 v125, v125
    v_exp_f32 v126, v126
    v_exp_f32 v127, v127
    v_exp_f32 v128, v128
    v_exp_f32 v129, v129
    v_smfmac_f32_32x32x32_bf16 v[160:175], v[68:71], v[120:127], v2
    ds_read_b128 v[56:59], v3 offset:9472
    v_exp_f32 v130, v130
    v_exp_f32 v131, v131
    v_exp_f32 v132, v132
    v_mfma_f32_32x32x16_bf16 v[80:95], v[60:63], v[8:11], v[80:95]
    ds_read_b32 v18, v4 offset:9472
    v_exp_f32 v133, v133
    v_exp_f32 v134, v134
    v_exp_f32 v135, v135
    v_mfma_f32_32x32x16_bf16 v[96:111], v[60:63], v[12:15], v[96:111]
    v_exp_f32 v136, v136
    v_exp_f32 v137, v137
    v_exp_f32 v138, v138
    v_smfmac_f32_32x32x32_bf16 v[176:191], v[64:67], v[128:135], v2
    s_waitcnt lgkmcnt(0)
    v_exp_f32 v139, v139
    v_exp_f32 v140, v140
    v_exp_f32 v141, v141
    v_exp_f32 v142, v142
    v_exp_f32 v143, v143
    v_exp_f32 v80, v80
    v_exp_f32 v81, v81
    v_smfmac_f32_32x32x32_bf16 v[176:191], v[68:71], v[136:143], v2
    ds_read_b128 v[64:67], v5 offset:9472
    v_exp_f32 v82, v82
    v_exp_f32 v83, v83
    v_exp_f32 v84, v84
    v_mfma_f32_32x32x4_2b_bf16 v[112:143], v[20:21], v[156:157], 0 cbsz:1 abid:1
    v_exp_f32 v85, v85
    v_exp_f32 v86, v86
    v_exp_f32 v87, v87
    v_exp_f32 v88, v88
    v_exp_f32 v89, v89
    v_exp_f32 v90, v90
    v_exp_f32 v91, v91
    v_exp_f32 v92, v92
    v_smfmac_f32_32x32x32_bf16 v[24:39], v[72:75], v[80:87], v2
    ds_read_b128 v[68:71], v5 offset:10080
    v_exp_f32 v93, v93
    v_exp_f32 v94, v94
    v_exp_f32 v95, v95
    v_exp_f32 v96, v96
    v_exp_f32 v97, v97
    v_smfmac_f32_32x32x32_bf16 v[24:39], v[76:79], v[88:95], v2
    v_exp_f32 v98, v98
    v_exp_f32 v99, v99
    v_exp_f32 v100, v100
    v_mfma_f32_32x32x16_bf16 v[112:127], v[60:63], v[148:151], v[112:127]
    v_exp_f32 v101, v101
    v_exp_f32 v102, v102
    v_exp_f32 v103, v103
    v_mfma_f32_32x32x16_bf16 v[128:143], v[60:63], v[152:155], v[128:143]
    v_exp_f32 v104, v104
    v_exp_f32 v105, v105
    v_exp_f32 v106, v106
    v_smfmac_f32_32x32x32_bf16 v[40:55], v[72:75], v[96:103], v2
    v_exp_f32 v107, v107
    v_exp_f32 v108, v108
    v_exp_f32 v109, v109
    v_exp_f32 v110, v110
    v_exp_f32 v111, v111
    v_exp_f32 v112, v112
    v_exp_f32 v113, v113
    v_smfmac_f32_32x32x32_bf16 v[40:55], v[76:79], v[104:111], v2
    v_exp_f32 v114, v114
    v_exp_f32 v115, v115
    v_exp_f32 v116, v116
    v_mfma_f32_32x32x4_2b_bf16 v[80:111], v[18:19], v[16:17], 0 cbsz:1 abid:0
    v_exp_f32 v117, v117
    v_exp_f32 v118, v118
    v_exp_f32 v119, v119
    v_exp_f32 v120, v120
    v_exp_f32 v121, v121
    v_exp_f32 v122, v122
    v_exp_f32 v123, v123
    v_exp_f32 v124, v124
    v_smfmac_f32_32x32x32_bf16 v[160:175], v[72:75], v[112:119], v2
    v_exp_f32 v125, v125
    v_exp_f32 v126, v126
    v_exp_f32 v127, v127
    v_exp_f32 v128, v128
    v_exp_f32 v129, v129
    v_smfmac_f32_32x32x32_bf16 v[160:175], v[76:79], v[120:127], v2
    ds_read_b128 v[60:63], v3 offset:10496
    v_exp_f32 v130, v130
    v_exp_f32 v131, v131
    v_exp_f32 v132, v132
    v_mfma_f32_32x32x16_bf16 v[80:95], v[56:59], v[8:11], v[80:95]
    v_exp_f32 v133, v133
    v_exp_f32 v134, v134
    v_exp_f32 v135, v135
    v_mfma_f32_32x32x16_bf16 v[96:111], v[56:59], v[12:15], v[96:111]
    v_exp_f32 v136, v136
    v_exp_f32 v137, v137
    v_exp_f32 v138, v138
    v_smfmac_f32_32x32x32_bf16 v[176:191], v[72:75], v[128:135], v2
    s_waitcnt lgkmcnt(0)
    v_exp_f32 v139, v139
    v_exp_f32 v140, v140
    v_exp_f32 v141, v141
    v_exp_f32 v142, v142
    v_exp_f32 v143, v143
    v_exp_f32 v80, v80
    v_exp_f32 v81, v81
    v_smfmac_f32_32x32x32_bf16 v[176:191], v[76:79], v[136:143], v2
    ds_read_b128 v[72:75], v5 offset:10688
    v_exp_f32 v82, v82
    v_exp_f32 v83, v83
    v_exp_f32 v84, v84
    v_mfma_f32_32x32x4_2b_bf16 v[112:143], v[18:19], v[156:157], 0 cbsz:1 abid:0
    v_exp_f32 v85, v85
    v_exp_f32 v86, v86
    v_exp_f32 v87, v87
    v_exp_f32 v88, v88
    v_exp_f32 v89, v89
    v_exp_f32 v90, v90
    v_exp_f32 v91, v91
    v_exp_f32 v92, v92
    v_smfmac_f32_32x32x32_bf16 v[24:39], v[64:67], v[80:87], v2
    ds_read_b128 v[76:79], v5 offset:11296
    v_exp_f32 v93, v93
    v_exp_f32 v94, v94
    v_exp_f32 v95, v95
    v_exp_f32 v96, v96
    v_exp_f32 v97, v97
    v_smfmac_f32_32x32x32_bf16 v[24:39], v[68:71], v[88:95], v2
    v_exp_f32 v98, v98
    v_exp_f32 v99, v99
    v_exp_f32 v100, v100
    v_mfma_f32_32x32x16_bf16 v[112:127], v[56:59], v[148:151], v[112:127]
    v_exp_f32 v101, v101
    v_exp_f32 v102, v102
    v_exp_f32 v103, v103
    v_mfma_f32_32x32x16_bf16 v[128:143], v[56:59], v[152:155], v[128:143]
    v_exp_f32 v104, v104
    v_exp_f32 v105, v105
    v_exp_f32 v106, v106
    v_smfmac_f32_32x32x32_bf16 v[40:55], v[64:67], v[96:103], v2
    v_exp_f32 v107, v107
    v_exp_f32 v108, v108
    v_exp_f32 v109, v109
    v_exp_f32 v110, v110
    v_exp_f32 v111, v111
    v_exp_f32 v112, v112
    v_exp_f32 v113, v113
    v_smfmac_f32_32x32x32_bf16 v[40:55], v[68:71], v[104:111], v2
    v_exp_f32 v114, v114
    v_exp_f32 v115, v115
    v_exp_f32 v116, v116
    v_mfma_f32_32x32x4_2b_bf16 v[80:111], v[18:19], v[16:17], 0 cbsz:1 abid:1
    v_exp_f32 v117, v117
    v_exp_f32 v118, v118
    v_exp_f32 v119, v119
    v_exp_f32 v120, v120
    v_exp_f32 v121, v121
    v_exp_f32 v122, v122
    v_exp_f32 v123, v123
    v_exp_f32 v124, v124
    v_smfmac_f32_32x32x32_bf16 v[160:175], v[64:67], v[112:119], v2
    v_exp_f32 v125, v125
    v_exp_f32 v126, v126
    v_exp_f32 v127, v127
    v_exp_f32 v128, v128
    v_exp_f32 v129, v129
    v_smfmac_f32_32x32x32_bf16 v[160:175], v[68:71], v[120:127], v2
    ds_read_b128 v[56:59], v3 offset:14208
    v_exp_f32 v130, v130
    v_exp_f32 v131, v131
    v_exp_f32 v132, v132
    v_mfma_f32_32x32x16_bf16 v[80:95], v[60:63], v[8:11], v[80:95]
    ds_read_b32 v20, v4 offset:14208
    v_exp_f32 v133, v133
    v_exp_f32 v134, v134
    v_exp_f32 v135, v135
    v_mfma_f32_32x32x16_bf16 v[96:111], v[60:63], v[12:15], v[96:111]
    v_exp_f32 v136, v136
    v_exp_f32 v137, v137
    v_exp_f32 v138, v138
    v_smfmac_f32_32x32x32_bf16 v[176:191], v[64:67], v[128:135], v2
    s_waitcnt lgkmcnt(0)
    v_exp_f32 v139, v139
    v_exp_f32 v140, v140
    v_exp_f32 v141, v141
    v_exp_f32 v142, v142
    v_exp_f32 v143, v143
    v_exp_f32 v80, v80
    v_exp_f32 v81, v81
    v_smfmac_f32_32x32x32_bf16 v[176:191], v[68:71], v[136:143], v2
    ds_read_b128 v[64:67], v5 offset:14208
    v_exp_f32 v82, v82
    v_exp_f32 v83, v83
    v_exp_f32 v84, v84
    v_mfma_f32_32x32x4_2b_bf16 v[112:143], v[18:19], v[156:157], 0 cbsz:1 abid:1
    v_exp_f32 v85, v85
    v_exp_f32 v86, v86
    v_exp_f32 v87, v87
    v_exp_f32 v88, v88
    v_exp_f32 v89, v89
    v_exp_f32 v90, v90
    v_exp_f32 v91, v91
    v_exp_f32 v92, v92
    v_smfmac_f32_32x32x32_bf16 v[24:39], v[72:75], v[80:87], v2
    ds_read_b128 v[68:71], v5 offset:14816
    v_exp_f32 v93, v93
    v_exp_f32 v94, v94
    v_exp_f32 v95, v95
    v_exp_f32 v96, v96
    v_exp_f32 v97, v97
    v_smfmac_f32_32x32x32_bf16 v[24:39], v[76:79], v[88:95], v2
    v_exp_f32 v98, v98
    v_exp_f32 v99, v99
    v_exp_f32 v100, v100
    v_mfma_f32_32x32x16_bf16 v[112:127], v[60:63], v[148:151], v[112:127]
    v_exp_f32 v101, v101
    v_exp_f32 v102, v102
    v_exp_f32 v103, v103
    v_mfma_f32_32x32x16_bf16 v[128:143], v[60:63], v[152:155], v[128:143]
    v_exp_f32 v104, v104
    v_exp_f32 v105, v105
    v_exp_f32 v106, v106
    v_smfmac_f32_32x32x32_bf16 v[40:55], v[72:75], v[96:103], v2
    v_exp_f32 v107, v107
    v_exp_f32 v108, v108
    v_exp_f32 v109, v109
    v_exp_f32 v110, v110
    v_exp_f32 v111, v111
    v_exp_f32 v112, v112
    v_exp_f32 v113, v113
    v_smfmac_f32_32x32x32_bf16 v[40:55], v[76:79], v[104:111], v2
    v_exp_f32 v114, v114
    v_exp_f32 v115, v115
    v_exp_f32 v116, v116
    v_mfma_f32_32x32x4_2b_bf16 v[80:111], v[20:21], v[16:17], 0 cbsz:1 abid:0
    v_exp_f32 v117, v117
    v_exp_f32 v118, v118
    v_exp_f32 v119, v119
    v_exp_f32 v120, v120
    v_exp_f32 v121, v121
    v_exp_f32 v122, v122
    v_exp_f32 v123, v123
    v_exp_f32 v124, v124
    v_smfmac_f32_32x32x32_bf16 v[160:175], v[72:75], v[112:119], v2
    v_exp_f32 v125, v125
    v_exp_f32 v126, v126
    v_exp_f32 v127, v127
    v_exp_f32 v128, v128
    v_exp_f32 v129, v129
    v_smfmac_f32_32x32x32_bf16 v[160:175], v[76:79], v[120:127], v2
    ds_read_b128 v[60:63], v3 offset:15232
    v_exp_f32 v130, v130
    v_exp_f32 v131, v131
    v_exp_f32 v132, v132
    v_mfma_f32_32x32x16_bf16 v[80:95], v[56:59], v[8:11], v[80:95]
    v_exp_f32 v133, v133
    v_exp_f32 v134, v134
    v_exp_f32 v135, v135
    v_mfma_f32_32x32x16_bf16 v[96:111], v[56:59], v[12:15], v[96:111]
    v_exp_f32 v136, v136
    v_exp_f32 v137, v137
    v_exp_f32 v138, v138
    v_smfmac_f32_32x32x32_bf16 v[176:191], v[72:75], v[128:135], v2
    s_waitcnt lgkmcnt(0)
    v_exp_f32 v139, v139
    v_exp_f32 v140, v140
    v_exp_f32 v141, v141
    v_exp_f32 v142, v142
    v_exp_f32 v143, v143
    v_exp_f32 v80, v80
    v_exp_f32 v81, v81
    v_smfmac_f32_32x32x32_bf16 v[176:191], v[76:79], v[136:143], v2
    ds_read_b128 v[72:75], v5 offset:15424
    v_exp_f32 v82, v82
    v_exp_f32 v83, v83
    v_exp_f32 v84, v84
    v_mfma_f32_32x32x4_2b_bf16 v[112:143], v[20:21], v[156:157], 0 cbsz:1 abid:0
    v_exp_f32 v85, v85
    v_exp_f32 v86, v86
    v_exp_f32 v87, v87
    v_exp_f32 v88, v88
    v_exp_f32 v89, v89
    v_exp_f32 v90, v90
    v_exp_f32 v91, v91
    v_exp_f32 v92, v92
    v_smfmac_f32_32x32x32_bf16 v[24:39], v[64:67], v[80:87], v2
    ds_read_b128 v[76:79], v5 offset:16032
    v_exp_f32 v93, v93
    v_exp_f32 v94, v94
    v_exp_f32 v95, v95
    v_exp_f32 v96, v96
    v_exp_f32 v97, v97
    v_smfmac_f32_32x32x32_bf16 v[24:39], v[68:71], v[88:95], v2
    v_exp_f32 v98, v98
    v_exp_f32 v99, v99
    v_exp_f32 v100, v100
    v_mfma_f32_32x32x16_bf16 v[112:127], v[56:59], v[148:151], v[112:127]
    v_exp_f32 v101, v101
    v_exp_f32 v102, v102
    v_exp_f32 v103, v103
    v_mfma_f32_32x32x16_bf16 v[128:143], v[56:59], v[152:155], v[128:143]
    v_exp_f32 v104, v104
    v_exp_f32 v105, v105
    v_exp_f32 v106, v106
    v_smfmac_f32_32x32x32_bf16 v[40:55], v[64:67], v[96:103], v2
    v_exp_f32 v107, v107
    v_exp_f32 v108, v108
    v_exp_f32 v109, v109
    v_exp_f32 v110, v110
    v_exp_f32 v111, v111
    v_exp_f32 v112, v112
    v_exp_f32 v113, v113
    v_smfmac_f32_32x32x32_bf16 v[40:55], v[68:71], v[104:111], v2
    v_exp_f32 v114, v114
    v_exp_f32 v115, v115
    v_exp_f32 v116, v116
    v_mfma_f32_32x32x4_2b_bf16 v[80:111], v[20:21], v[16:17], 0 cbsz:1 abid:1
    v_exp_f32 v117, v117
    v_exp_f32 v118, v118
    v_exp_f32 v119, v119
    v_exp_f32 v120, v120
    v_exp_f32 v121, v121
    v_exp_f32 v122, v122
    v_exp_f32 v123, v123
    v_exp_f32 v124, v124
    v_smfmac_f32_32x32x32_bf16 v[160:175], v[64:67], v[112:119], v2
    v_exp_f32 v125, v125
    v_exp_f32 v126, v126
    v_exp_f32 v127, v127
    v_exp_f32 v128, v128
    v_exp_f32 v129, v129
    v_smfmac_f32_32x32x32_bf16 v[160:175], v[68:71], v[120:127], v2
    ds_read_b128 v[56:59], v3 offset:18944
    v_exp_f32 v130, v130
    v_exp_f32 v131, v131
    v_exp_f32 v132, v132
    v_mfma_f32_32x32x16_bf16 v[80:95], v[60:63], v[8:11], v[80:95]
    ds_read_b32 v18, v4 offset:18944
    v_exp_f32 v133, v133
    v_exp_f32 v134, v134
    v_exp_f32 v135, v135
    v_mfma_f32_32x32x16_bf16 v[96:111], v[60:63], v[12:15], v[96:111]
    v_exp_f32 v136, v136
    v_exp_f32 v137, v137
    v_exp_f32 v138, v138
    v_smfmac_f32_32x32x32_bf16 v[176:191], v[64:67], v[128:135], v2
    s_waitcnt lgkmcnt(0)
    v_exp_f32 v139, v139
    v_exp_f32 v140, v140
    v_exp_f32 v141, v141
    v_exp_f32 v142, v142
    v_exp_f32 v143, v143
    v_exp_f32 v80, v80
    v_exp_f32 v81, v81
    v_smfmac_f32_32x32x32_bf16 v[176:191], v[68:71], v[136:143], v2
    ds_read_b128 v[64:67], v5 offset:18944
    v_exp_f32 v82, v82
    v_exp_f32 v83, v83
    v_exp_f32 v84, v84
    v_mfma_f32_32x32x4_2b_bf16 v[112:143], v[20:21], v[156:157], 0 cbsz:1 abid:1
    v_exp_f32 v85, v85
    v_exp_f32 v86, v86
    v_exp_f32 v87, v87
    v_exp_f32 v88, v88
    v_exp_f32 v89, v89
    v_exp_f32 v90, v90
    v_exp_f32 v91, v91
    v_exp_f32 v92, v92
    v_smfmac_f32_32x32x32_bf16 v[24:39], v[72:75], v[80:87], v2
    ds_read_b128 v[68:71], v5 offset:19552
    v_exp_f32 v93, v93
    v_exp_f32 v94, v94
    v_exp_f32 v95, v95
    v_exp_f32 v96, v96
    v_exp_f32 v97, v97
    v_smfmac_f32_32x32x32_bf16 v[24:39], v[76:79], v[88:95], v2
    v_exp_f32 v98, v98
    v_exp_f32 v99, v99
    v_exp_f32 v100, v100
    v_mfma_f32_32x32x16_bf16 v[112:127], v[60:63], v[148:151], v[112:127]
    v_exp_f32 v101, v101
    v_exp_f32 v102, v102
    v_exp_f32 v103, v103
    v_mfma_f32_32x32x16_bf16 v[128:143], v[60:63], v[152:155], v[128:143]
    v_exp_f32 v104, v104
    v_exp_f32 v105, v105
    v_exp_f32 v106, v106
    v_smfmac_f32_32x32x32_bf16 v[40:55], v[72:75], v[96:103], v2
    v_exp_f32 v107, v107
    v_exp_f32 v108, v108
    v_exp_f32 v109, v109
    v_exp_f32 v110, v110
    v_exp_f32 v111, v111
    v_exp_f32 v112, v112
    v_exp_f32 v113, v113
    v_smfmac_f32_32x32x32_bf16 v[40:55], v[76:79], v[104:111], v2
    s_sub_u32 s15, s15, 1
    v_exp_f32 v114, v114
    v_exp_f32 v115, v115
    v_exp_f32 v116, v116
    v_mfma_f32_32x32x4_2b_bf16 v[80:111], v[18:19], v[16:17], 0 cbsz:1 abid:0
    v_exp_f32 v117, v117
    v_exp_f32 v118, v118
    v_exp_f32 v119, v119
    v_exp_f32 v120, v120
    v_exp_f32 v121, v121
    v_exp_f32 v122, v122
    v_exp_f32 v123, v123
    v_exp_f32 v124, v124
    v_smfmac_f32_32x32x32_bf16 v[160:175], v[72:75], v[112:119], v2
    s_cmp_lg_u32 s15, s75
    v_exp_f32 v125, v125
    v_exp_f32 v126, v126
    v_exp_f32 v127, v127
    v_exp_f32 v128, v128
    v_exp_f32 v129, v129
    v_smfmac_f32_32x32x32_bf16 v[160:175], v[76:79], v[120:127], v2
    ds_read_b128 v[60:63], v3 offset:19968
    v_exp_f32 v130, v130
    v_exp_f32 v131, v131
    v_exp_f32 v132, v132
    v_mfma_f32_32x32x16_bf16 v[80:95], v[56:59], v[8:11], v[80:95]
    v_exp_f32 v133, v133
    v_exp_f32 v134, v134
    v_exp_f32 v135, v135
    v_mfma_f32_32x32x16_bf16 v[96:111], v[56:59], v[12:15], v[96:111]
    v_exp_f32 v136, v136
    v_exp_f32 v137, v137
    v_exp_f32 v138, v138
    v_smfmac_f32_32x32x32_bf16 v[176:191], v[72:75], v[128:135], v2
    s_waitcnt lgkmcnt(0)
    v_exp_f32 v139, v139
    v_exp_f32 v140, v140
    v_exp_f32 v141, v141
    v_exp_f32 v142, v142
    v_exp_f32 v143, v143
    v_add_u32 v3, 18944, v3
    v_add_u32 v4, 18944, v4
    v_add_u32 v5, 18944, v5
    s_cbranch_scc1 L_main
    s_cmp_eq_u32 s15, 1
    s_cbranch_scc1 L_last
    s_barrier
    s_mov_b32 s75, 1
    s_branch L_main
L_last:
    s_barrier
    ds_read_b32 v23, v146 offset:4
    ds_read_b32 v20, v4 offset:4736
    v_exp_f32 v80, v80
    v_exp_f32 v81, v81
    v_smfmac_f32_32x32x32_bf16 v[176:191], v[76:79], v[136:143], v2
    ds_read_b128 v[72:75], v5 offset:1216
    v_exp_f32 v82, v82
    v_exp_f32 v83, v83
    v_exp_f32 v84, v84
    v_mfma_f32_32x32x4_2b_bf16 v[112:143], v[18:19], v[16:17], 0 cbsz:1 abid:1
    v_exp_f32 v85, v85
    v_exp_f32 v86, v86
    v_exp_f32 v87, v87
    v_exp_f32 v88, v88
    v_exp_f32 v89, v89
    v_exp_f32 v90, v90
    v_exp_f32 v91, v91
    v_exp_f32 v92, v92
    v_smfmac_f32_32x32x32_bf16 v[24:39], v[64:67], v[80:87], v2
    ds_read_b128 v[76:79], v5 offset:1824
    v_exp_f32 v93, v93
    v_exp_f32 v94, v94
    v_exp_f32 v95, v95
    v_exp_f32 v96, v96
    v_exp_f32 v97, v97
    v_smfmac_f32_32x32x32_bf16 v[24:39], v[68:71], v[88:95], v2
    ds_read_b128 v[56:59], v3 offset:4736
    v_exp_f32 v98, v98
    v_exp_f32 v99, v99
    v_exp_f32 v100, v100
    v_mfma_f32_32x32x16_bf16 v[112:127], v[60:63], v[8:11], v[112:127]
    v_exp_f32 v101, v101
    v_exp_f32 v102, v102
    v_exp_f32 v103, v103
    v_mfma_f32_32x32x16_bf16 v[128:143], v[60:63], v[12:15], v[128:143]
    v_exp_f32 v104, v104
    v_exp_f32 v105, v105
    v_exp_f32 v106, v106
    v_smfmac_f32_32x32x32_bf16 v[40:55], v[64:67], v[96:103], v2
    s_waitcnt lgkmcnt(0)
    v_exp_f32 v107, v107
    v_exp_f32 v108, v108
    v_exp_f32 v109, v109
    v_exp_f32 v110, v110
    v_exp_f32 v111, v111
    v_exp_f32 v112, v112
    v_exp_f32 v113, v113
    v_smfmac_f32_32x32x32_bf16 v[40:55], v[68:71], v[104:111], v2
    ds_read_b128 v[64:67], v5 offset:4736
    v_exp_f32 v114, v114
    v_exp_f32 v115, v115
    v_exp_f32 v116, v116
    v_mfma_f32_32x32x4_2b_bf16 v[80:111], v[20:21], v[16:17], 0 cbsz:1 abid:0
    v_exp_f32 v117, v117
    v_exp_f32 v118, v118
    v_exp_f32 v119, v119
    v_exp_f32 v120, v120
    v_exp_f32 v121, v121
    v_exp_f32 v122, v122
    v_exp_f32 v123, v123
    v_exp_f32 v124, v124
    v_smfmac_f32_32x32x32_bf16 v[24:39], v[72:75], v[112:119], v2
    ds_read_b128 v[68:71], v5 offset:5344
    v_exp_f32 v125, v125
    v_exp_f32 v126, v126
    v_exp_f32 v127, v127
    v_exp_f32 v128, v128
    v_exp_f32 v129, v129
    v_smfmac_f32_32x32x32_bf16 v[24:39], v[76:79], v[120:127], v2
    ds_read_b128 v[60:63], v3 offset:5760
    v_exp_f32 v130, v130
    v_exp_f32 v131, v131
    v_exp_f32 v132, v132
    v_mfma_f32_32x32x16_bf16 v[80:95], v[56:59], v[8:11], v[80:95]
    ds_read_b32 v18, v4 offset:9472
    v_exp_f32 v133, v133
    v_exp_f32 v134, v134
    v_exp_f32 v135, v135
    v_mfma_f32_32x32x16_bf16 v[96:111], v[56:59], v[12:15], v[96:111]
    v_exp_f32 v136, v136
    v_exp_f32 v137, v137
    v_exp_f32 v138, v138
    v_smfmac_f32_32x32x32_bf16 v[40:55], v[72:75], v[128:135], v2
    s_waitcnt lgkmcnt(0)
    v_exp_f32 v139, v139
    v_exp_f32 v140, v140
    v_exp_f32 v141, v141
    v_exp_f32 v142, v142
    v_exp_f32 v143, v143
    v_exp_f32 v80, v80
    v_exp_f32 v81, v81
    v_smfmac_f32_32x32x32_bf16 v[40:55], v[76:79], v[136:143], v2
    ds_read_b128 v[72:75], v5 offset:5952
    v_exp_f32 v82, v82
    v_exp_f32 v83, v83
    v_exp_f32 v84, v84
    v_mfma_f32_32x32x4_2b_bf16 v[112:143], v[20:21], v[16:17], 0 cbsz:1 abid:1
    v_exp_f32 v85, v85
    v_exp_f32 v86, v86
    v_exp_f32 v87, v87
    v_exp_f32 v88, v88
    v_exp_f32 v89, v89
    v_exp_f32 v90, v90
    v_exp_f32 v91, v91
    v_exp_f32 v92, v92
    v_smfmac_f32_32x32x32_bf16 v[24:39], v[64:67], v[80:87], v2
    ds_read_b128 v[76:79], v5 offset:6560
    v_exp_f32 v93, v93
    v_exp_f32 v94, v94
    v_exp_f32 v95, v95
    v_exp_f32 v96, v96
    v_exp_f32 v97, v97
    v_smfmac_f32_32x32x32_bf16 v[24:39], v[68:71], v[88:95], v2
    ds_read_b128 v[56:59], v3 offset:9472
    v_exp_f32 v98, v98
    v_exp_f32 v99, v99
    v_exp_f32 v100, v100
    v_mfma_f32_32x32x16_bf16 v[112:127], v[60:63], v[8:11], v[112:127]
    v_exp_f32 v101, v101
    v_exp_f32 v102, v102
    v_exp_f32 v103, v103
    v_mfma_f32_32x32x16_bf16 v[128:143], v[60:63], v[12:15], v[128:143]
    v_exp_f32 v104, v104
    v_exp_f32 v105, v105
    v_exp_f32 v106, v106
    v_smfmac_f32_32x32x32_bf16 v[40:55], v[64:67], v[96:103], v2
    s_waitcnt lgkmcnt(0)
    v_exp_f32 v107, v107
    v_exp_f32 v108, v108
    v_exp_f32 v109, v109
    v_exp_f32 v110, v110
    v_exp_f32 v111, v111
    v_exp_f32 v112, v112
    v_exp_f32 v113, v113
    v_smfmac_f32_32x32x32_bf16 v[40:55], v[68:71], v[104:111], v2
    ds_read_b128 v[64:67], v5 offset:9472
    v_exp_f32 v114, v114
    v_exp_f32 v115, v115
    v_exp_f32 v116, v116
    v_mfma_f32_32x32x4_2b_bf16 v[80:111], v[18:19], v[16:17], 0 cbsz:1 abid:0
    v_exp_f32 v117, v117
    v_exp_f32 v118, v118
    v_exp_f32 v119, v119
    v_exp_f32 v120, v120
    v_exp_f32 v121, v121
    v_exp_f32 v122, v122
    v_exp_f32 v123, v123
    v_exp_f32 v124, v124
    v_smfmac_f32_32x32x32_bf16 v[24:39], v[72:75], v[112:119], v2
    ds_read_b128 v[68:71], v5 offset:10080
    v_exp_f32 v125, v125
    v_exp_f32 v126, v126
    v_exp_f32 v127, v127
    v_exp_f32 v128, v128
    v_exp_f32 v129, v129
    v_smfmac_f32_32x32x32_bf16 v[24:39], v[76:79], v[120:127], v2
    ds_read_b128 v[60:63], v3 offset:10496
    v_exp_f32 v130, v130
    v_exp_f32 v131, v131
    v_exp_f32 v132, v132
    v_mfma_f32_32x32x16_bf16 v[80:95], v[56:59], v[8:11], v[80:95]
    ds_read_b32 v20, v4 offset:14208
    v_exp_f32 v133, v133
    v_exp_f32 v134, v134
    v_exp_f32 v135, v135
    v_mfma_f32_32x32x16_bf16 v[96:111], v[56:59], v[12:15], v[96:111]
    v_exp_f32 v136, v136
    v_exp_f32 v137, v137
    v_exp_f32 v138, v138
    v_smfmac_f32_32x32x32_bf16 v[40:55], v[72:75], v[128:135], v2
    s_waitcnt lgkmcnt(0)
    v_exp_f32 v139, v139
    v_exp_f32 v140, v140
    v_exp_f32 v141, v141
    v_exp_f32 v142, v142
    v_exp_f32 v143, v143
    v_exp_f32 v80, v80
    v_exp_f32 v81, v81
    v_smfmac_f32_32x32x32_bf16 v[40:55], v[76:79], v[136:143], v2
    ds_read_b128 v[72:75], v5 offset:10688
    v_exp_f32 v82, v82
    v_exp_f32 v83, v83
    v_exp_f32 v84, v84
    v_mfma_f32_32x32x4_2b_bf16 v[112:143], v[18:19], v[16:17], 0 cbsz:1 abid:1
    v_exp_f32 v85, v85
    v_exp_f32 v86, v86
    v_exp_f32 v87, v87
    v_exp_f32 v88, v88
    v_exp_f32 v89, v89
    v_exp_f32 v90, v90
    v_exp_f32 v91, v91
    v_exp_f32 v92, v92
    v_smfmac_f32_32x32x32_bf16 v[24:39], v[64:67], v[80:87], v2
    ds_read_b128 v[76:79], v5 offset:11296
    v_exp_f32 v93, v93
    v_exp_f32 v94, v94
    v_exp_f32 v95, v95
    v_exp_f32 v96, v96
    v_exp_f32 v97, v97
    v_smfmac_f32_32x32x32_bf16 v[24:39], v[68:71], v[88:95], v2
    ds_read_b128 v[56:59], v3 offset:14208
    v_exp_f32 v98, v98
    v_exp_f32 v99, v99
    v_exp_f32 v100, v100
    v_mfma_f32_32x32x16_bf16 v[112:127], v[60:63], v[8:11], v[112:127]
    v_exp_f32 v101, v101
    v_exp_f32 v102, v102
    v_exp_f32 v103, v103
    v_mfma_f32_32x32x16_bf16 v[128:143], v[60:63], v[12:15], v[128:143]
    v_exp_f32 v104, v104
    v_exp_f32 v105, v105
    v_exp_f32 v106, v106
    v_smfmac_f32_32x32x32_bf16 v[40:55], v[64:67], v[96:103], v2
    s_waitcnt lgkmcnt(0)
    v_exp_f32 v107, v107
    v_exp_f32 v108, v108
    v_exp_f32 v109, v109
    v_exp_f32 v110, v110
    v_exp_f32 v111, v111
    v_exp_f32 v112, v112
    v_exp_f32 v113, v113
    v_smfmac_f32_32x32x32_bf16 v[40:55], v[68:71], v[104:111], v2
    ds_read_b128 v[64:67], v5 offset:14208
    v_exp_f32 v114, v114
    v_exp_f32 v115, v115
    v_exp_f32 v116, v116
    v_mfma_f32_32x32x4_2b_bf16 v[80:111], v[20:21], v[16:17], 0 cbsz:1 abid:0
    v_exp_f32 v117, v117
    v_exp_f32 v118, v118
    v_exp_f32 v119, v119
    v_exp_f32 v120, v120
    v_exp_f32 v121, v121
    v_exp_f32 v122, v122
    v_exp_f32 v123, v123
    v_exp_f32 v124, v124
    v_smfmac_f32_32x32x32_bf16 v[24:39], v[72:75], v[112:119], v2
    ds_read_b128 v[68:71], v5 offset:14816
    v_exp_f32 v125, v125
    v_exp_f32 v126, v126
    v_exp_f32 v127, v127
    v_exp_f32 v128, v128
    v_exp_f32 v129, v129
    v_smfmac_f32_32x32x32_bf16 v[24:39], v[76:79], v[120:127], v2
    ds_read_b128 v[60:63], v3 offset:15232
    v_exp_f32 v130, v130
    v_exp_f32 v131, v131
    v_exp_f32 v132, v132
    v_mfma_f32_32x32x16_bf16 v[80:95], v[56:59], v[8:11], v[80:95]
    ds_read_b32 v18, v4 offset:0
    v_exp_f32 v133, v133
    v_exp_f32 v134, v134
    v_exp_f32 v135, v135
    v_mfma_f32_32x32x16_bf16 v[96:111], v[56:59], v[12:15], v[96:111]
    v_exp_f32 v136, v136
    v_exp_f32 v137, v137
    v_exp_f32 v138, v138
    v_smfmac_f32_32x32x32_bf16 v[40:55], v[72:75], v[128:135], v2
    s_waitcnt lgkmcnt(0)
    v_exp_f32 v139, v139
    v_exp_f32 v140, v140
    v_exp_f32 v141, v141
    v_exp_f32 v142, v142
    v_exp_f32 v143, v143
    v_exp_f32 v80, v80
    v_exp_f32 v81, v81
    v_smfmac_f32_32x32x32_bf16 v[40:55], v[76:79], v[136:143], v2
    ds_read_b128 v[72:75], v5 offset:15424
    v_exp_f32 v82, v82
    v_exp_f32 v83, v83
    v_exp_f32 v84, v84
    v_mfma_f32_32x32x4_2b_bf16 v[112:143], v[20:21], v[16:17], 0 cbsz:1 abid:1
    v_exp_f32 v85, v85
    v_exp_f32 v86, v86
    v_exp_f32 v87, v87
    v_exp_f32 v88, v88
    v_exp_f32 v89, v89
    v_exp_f32 v90, v90
    v_exp_f32 v91, v91
    v_exp_f32 v92, v92
    v_smfmac_f32_32x32x32_bf16 v[24:39], v[64:67], v[80:87], v2
    ds_read_b128 v[76:79], v5 offset:16032
    v_exp_f32 v93, v93
    v_exp_f32 v94, v94
    v_exp_f32 v95, v95
    v_exp_f32 v96, v96
    v_exp_f32 v97, v97
    v_smfmac_f32_32x32x32_bf16 v[24:39], v[68:71], v[88:95], v2
    ds_read_b128 v[56:59], v3 offset:0
    v_exp_f32 v98, v98
    v_exp_f32 v99, v99
    v_exp_f32 v100, v100
    v_mfma_f32_32x32x16_bf16 v[112:127], v[60:63], v[8:11], v[112:127]
    v_exp_f32 v101, v101
    v_exp_f32 v102, v102
    v_exp_f32 v103, v103
    v_mfma_f32_32x32x16_bf16 v[128:143], v[60:63], v[12:15], v[128:143]
    v_exp_f32 v104, v104
    v_exp_f32 v105, v105
    v_exp_f32 v106, v106
    v_smfmac_f32_32x32x32_bf16 v[40:55], v[64:67], v[96:103], v2
    s_waitcnt lgkmcnt(0)
    v_exp_f32 v107, v107
    v_exp_f32 v108, v108
    v_exp_f32 v109, v109
    v_exp_f32 v110, v110
    v_exp_f32 v111, v111
    v_exp_f32 v112, v112
    v_exp_f32 v113, v113
    v_smfmac_f32_32x32x32_bf16 v[40:55], v[68:71], v[104:111], v2
    ds_read_b128 v[64:67], v5 offset:0
    v_exp_f32 v114, v114
    v_exp_f32 v115, v115
    v_exp_f32 v116, v116
    v_mfma_f32_32x32x4_2b_bf16 v[80:111], v[18:19], v[156:157], 0 cbsz:1 abid:0
    v_exp_f32 v117, v117
    v_exp_f32 v118, v118
    v_exp_f32 v119, v119
    v_exp_f32 v120, v120
    v_exp_f32 v121, v121
    v_exp_f32 v122, v122
    v_exp_f32 v123, v123
    v_exp_f32 v124, v124
    v_smfmac_f32_32x32x32_bf16 v[24:39], v[72:75], v[112:119], v2
    ds_read_b128 v[68:71], v5 offset:608
    v_exp_f32 v125, v125
    v_exp_f32 v126, v126
    v_exp_f32 v127, v127
    v_exp_f32 v128, v128
    v_exp_f32 v129, v129
    v_smfmac_f32_32x32x32_bf16 v[24:39], v[76:79], v[120:127], v2
    ds_read_b128 v[60:63], v3 offset:1024
    v_exp_f32 v130, v130
    v_exp_f32 v131, v131
    v_exp_f32 v132, v132
    v_mfma_f32_32x32x16_bf16 v[80:95], v[56:59], v[148:151], v[80:95]
    ds_read_b32 v20, v4 offset:4736
    v_exp_f32 v133, v133
    v_exp_f32 v134, v134
    v_exp_f32 v135, v135
    v_mfma_f32_32x32x16_bf16 v[96:111], v[56:59], v[152:155], v[96:111]
    v_exp_f32 v136, v136
    v_exp_f32 v137, v137
    v_exp_f32 v138, v138
    v_smfmac_f32_32x32x32_bf16 v[40:55], v[72:75], v[128:135], v2
    s_waitcnt lgkmcnt(0)
    v_exp_f32 v139, v139
    v_exp_f32 v140, v140
    v_exp_f32 v141, v141
    v_exp_f32 v142, v142
    v_exp_f32 v143, v143
    v_exp_f32 v80, v80
    v_exp_f32 v81, v81
    v_smfmac_f32_32x32x32_bf16 v[40:55], v[76:79], v[136:143], v2
    ds_read_b128 v[72:75], v5 offset:1216
    v_exp_f32 v82, v82
    v_exp_f32 v83, v83
    v_exp_f32 v84, v84
    v_mfma_f32_32x32x4_2b_bf16 v[112:143], v[18:19], v[156:157], 0 cbsz:1 abid:1
    v_exp_f32 v85, v85
    v_exp_f32 v86, v86
    v_exp_f32 v87, v87
    v_exp_f32 v88, v88
    v_exp_f32 v89, v89
    v_exp_f32 v90, v90
    v_exp_f32 v91, v91
    v_exp_f32 v92, v92
    v_smfmac_f32_32x32x32_bf16 v[160:175], v[64:67], v[80:87], v2
    ds_read_b128 v[76:79], v5 offset:1824
    v_exp_f32 v93, v93
    v_exp_f32 v94, v94
    v_exp_f32 v95, v95
    v_exp_f32 v96, v96
    v_exp_f32 v97, v97
    v_smfmac_f32_32x32x32_bf16 v[160:175], v[68:71], v[88:95], v2
    ds_read_b128 v[56:59], v3 offset:4736
    v_exp_f32 v98, v98
    v_exp_f32 v99, v99
    v_exp_f32 v100, v100
    v_mfma_f32_32x32x16_bf16 v[112:127], v[60:63], v[148:151], v[112:127]
    v_exp_f32 v101, v101
    v_exp_f32 v102, v102
    v_exp_f32 v103, v103
    v_mfma_f32_32x32x16_bf16 v[128:143], v[60:63], v[152:155], v[128:143]
    v_exp_f32 v104, v104
    v_exp_f32 v105, v105
    v_exp_f32 v106, v106
    v_smfmac_f32_32x32x32_bf16 v[176:191], v[64:67], v[96:103], v2
    s_waitcnt lgkmcnt(0)
    v_exp_f32 v107, v107
    v_exp_f32 v108, v108
    v_exp_f32 v109, v109
    v_exp_f32 v110, v110
    v_exp_f32 v111, v111
    v_rcp_f32 v6, v33
    s_nop 0
    v_mul_f32 v24, v24, v6
    v_mul_f32 v25, v25, v6
    v_mul_f32 v26, v26, v6
    v_mul_f32 v27, v27, v6
    v_mul_f32 v28, v28, v6
    v_mul_f32 v29, v29, v6
    v_mul_f32 v30, v30, v6
    v_mul_f32 v31, v31, v6
    v_mul_f32 v32, v32, v6
    v_cvt_pk_bf16_f32 v192, v24, v25
    v_cvt_pk_bf16_f32 v193, v26, v27
    v_cvt_pk_bf16_f32 v194, v28, v29
    v_rcp_f32 v7, v49
    v_cvt_pk_bf16_f32 v195, v30, v31
    v_mul_f32 v40, v40, v7
    v_mul_f32 v41, v41, v7
    v_mul_f32 v42, v42, v7
    v_mul_f32 v43, v43, v7
    v_mul_f32 v44, v44, v7
    v_mul_f32 v45, v45, v7
    v_mul_f32 v46, v46, v7
    v_mul_f32 v47, v47, v7
    v_mul_f32 v48, v48, v7
    v_cvt_pk_bf16_f32 v196, v32, v40
    v_cvt_pk_bf16_f32 v197, v41, v42
    v_cvt_pk_bf16_f32 v198, v43, v44
    v_cvt_pk_bf16_f32 v199, v45, v46
    v_cvt_pk_bf16_f32 v200, v47, v48
L_pub20:
    v_add_u32 v201, 12288, v144
    v_add_u32 v202, 77824, v145
    ds_write_b128 v201, v[192:195] offset:0
    ds_write_b128 v201, v[196:199] offset:256
    ds_write_b32 v202, v200 offset:0
    v_exp_f32 v112, v112
    v_exp_f32 v113, v113
    v_smfmac_f32_32x32x32_bf16 v[176:191], v[68:71], v[104:111], v2
    ds_read_b128 v[64:67], v5 offset:4736
    v_exp_f32 v114, v114
    v_exp_f32 v115, v115
    v_exp_f32 v116, v116
    v_mfma_f32_32x32x4_2b_bf16 v[80:111], v[20:21], v[156:157], 0 cbsz:1 abid:0
    v_exp_f32 v117, v117
    v_exp_f32 v118, v118
    v_exp_f32 v119, v119
    v_exp_f32 v120, v120
    v_exp_f32 v121, v121
    v_exp_f32 v122, v122
    v_exp_f32 v123, v123
    v_exp_f32 v124, v124
    v_smfmac_f32_32x32x32_bf16 v[160:175], v[72:75], v[112:119], v2
    ds_read_b128 v[68:71], v5 offset:5344
    v_exp_f32 v125, v125
    v_exp_f32 v126, v126
    v_exp_f32 v127, v127
    v_exp_f32 v128, v128
    v_exp_f32 v129, v129
    v_smfmac_f32_32x32x32_bf16 v[160:175], v[76:79], v[120:127], v2
    ds_read_b128 v[60:63], v3 offset:5760
    v_exp_f32 v130, v130
    v_exp_f32 v131, v131
    v_exp_f32 v132, v132
    v_mfma_f32_32x32x16_bf16 v[80:95], v[56:59], v[148:151], v[80:95]
    ds_read_b32 v18, v4 offset:9472
    v_exp_f32 v133, v133
    v_exp_f32 v134, v134
    v_exp_f32 v135, v135
    v_mfma_f32_32x32x16_bf16 v[96:111], v[56:59], v[152:155], v[96:111]
    v_exp_f32 v136, v136
    v_exp_f32 v137, v137
    v_exp_f32 v138, v138
    v_smfmac_f32_32x32x32_bf16 v[176:191], v[72:75], v[128:135], v2
    s_waitcnt lgkmcnt(0)
    v_exp_f32 v139, v139
    v_exp_f32 v140, v140
    v_exp_f32 v141, v141
    v_exp_f32 v142, v142
    v_exp_f32 v143, v143
    s_barrier
    v_exp_f32 v80, v80
    v_exp_f32 v81, v81
    v_smfmac_f32_32x32x32_bf16 v[176:191], v[76:79], v[136:143], v2
    ds_read_b128 v[72:75], v5 offset:5952
    v_exp_f32 v82, v82
    v_exp_f32 v83, v83
    v_exp_f32 v84, v84
    v_mfma_f32_32x32x4_2b_bf16 v[112:143], v[20:21], v[156:157], 0 cbsz:1 abid:1
    v_exp_f32 v85, v85
    v_exp_f32 v86, v86
    v_exp_f32 v87, v87
    v_exp_f32 v88, v88
    v_exp_f32 v89, v89
    v_exp_f32 v90, v90
    v_exp_f32 v91, v91
    v_exp_f32 v92, v92
    v_smfmac_f32_32x32x32_bf16 v[160:175], v[64:67], v[80:87], v2
    ds_read_b128 v[76:79], v5 offset:6560
    v_exp_f32 v93, v93
    v_exp_f32 v94, v94
    v_exp_f32 v95, v95
    v_exp_f32 v96, v96
    v_exp_f32 v97, v97
    v_smfmac_f32_32x32x32_bf16 v[160:175], v[68:71], v[88:95], v2
    ds_read_b128 v[56:59], v3 offset:9472
    v_exp_f32 v98, v98
    v_exp_f32 v99, v99
    v_exp_f32 v100, v100
    v_mfma_f32_32x32x16_bf16 v[112:127], v[60:63], v[148:151], v[112:127]
    v_exp_f32 v101, v101
    v_exp_f32 v102, v102
    v_exp_f32 v103, v103
    v_mfma_f32_32x32x16_bf16 v[128:143], v[60:63], v[152:155], v[128:143]
    v_exp_f32 v104, v104
    v_exp_f32 v105, v105
    v_exp_f32 v106, v106
    v_smfmac_f32_32x32x32_bf16 v[176:191], v[64:67], v[96:103], v2
    s_waitcnt lgkmcnt(0)
    v_exp_f32 v107, v107
    v_exp_f32 v108, v108
    v_exp_f32 v109, v109
    v_exp_f32 v110, v110
    v_exp_f32 v111, v111
    v_exp_f32 v112, v112
    v_exp_f32 v113, v113
    v_smfmac_f32_32x32x32_bf16 v[176:191], v[68:71], v[104:111], v2
    ds_read_b128 v[64:67], v5 offset:9472
    v_exp_f32 v114, v114
    v_exp_f32 v115, v115
    v_exp_f32 v116, v116
    v_mfma_f32_32x32x4_2b_bf16 v[80:111], v[18:19], v[156:157], 0 cbsz:1 abid:0
    v_exp_f32 v117, v117
    v_exp_f32 v118, v118
    v_exp_f32 v119, v119
    v_exp_f32 v120, v120
    v_exp_f32 v121, v121
    v_exp_f32 v122, v122
    v_exp_f32 v123, v123
    v_exp_f32 v124, v124
    v_smfmac_f32_32x32x32_bf16 v[160:175], v[72:75], v[112:119], v2
    ds_read_b128 v[68:71], v5 offset:10080
    v_exp_f32 v125, v125
    v_exp_f32 v126, v126
    v_exp_f32 v127, v127
    v_exp_f32 v128, v128
    v_exp_f32 v129, v129
    v_smfmac_f32_32x32x32_bf16 v[160:175], v[76:79], v[120:127], v2
    ds_read_b128 v[60:63], v3 offset:10496
    v_exp_f32 v130, v130
    v_exp_f32 v131, v131
    v_exp_f32 v132, v132
    v_mfma_f32_32x32x16_bf16 v[80:95], v[56:59], v[148:151], v[80:95]
    ds_read_b32 v20, v4 offset:14208
    v_exp_f32 v133, v133
    v_exp_f32 v134, v134
    v_exp_f32 v135, v135
    v_mfma_f32_32x32x16_bf16 v[96:111], v[56:59], v[152:155], v[96:111]
    v_exp_f32 v136, v136
    v_exp_f32 v137, v137
    v_exp_f32 v138, v138
    v_smfmac_f32_32x32x32_bf16 v[176:191], v[72:75], v[128:135], v2
    s_waitcnt lgkmcnt(0)
    v_exp_f32 v139, v139
    v_exp_f32 v140, v140
    v_exp_f32 v141, v141
    v_exp_f32 v142, v142
    v_exp_f32 v143, v143
    v_exp_f32 v80, v80
    v_exp_f32 v81, v81
    v_smfmac_f32_32x32x32_bf16 v[176:191], v[76:79], v[136:143], v2
    ds_read_b128 v[72:75], v5 offset:10688
    v_exp_f32 v82, v82
    v_exp_f32 v83, v83
    v_exp_f32 v84, v84
    v_mfma_f32_32x32x4_2b_bf16 v[112:143], v[18:19], v[156:157], 0 cbsz:1 abid:1
    v_exp_f32 v85, v85
    v_exp_f32 v86, v86
    v_exp_f32 v87, v87
    v_exp_f32 v88, v88
    v_exp_f32 v89, v89
    v_exp_f32 v90, v90
    v_exp_f32 v91, v91
    v_exp_f32 v92, v92
    v_smfmac_f32_32x32x32_bf16 v[160:175], v[64:67], v[80:87], v2
    ds_read_b128 v[76:79], v5 offset:11296
    v_exp_f32 v93, v93
    v_exp_f32 v94, v94
    v_exp_f32 v95, v95
    v_exp_f32 v96, v96
    v_exp_f32 v97, v97
    v_smfmac_f32_32x32x32_bf16 v[160:175], v[68:71], v[88:95], v2
    ds_read_b128 v[56:59], v3 offset:14208
    v_exp_f32 v98, v98
    v_exp_f32 v99, v99
    v_exp_f32 v100, v100
    v_mfma_f32_32x32x16_bf16 v[112:127], v[60:63], v[148:151], v[112:127]
    v_exp_f32 v101, v101
    v_exp_f32 v102, v102
    v_exp_f32 v103, v103
    v_mfma_f32_32x32x16_bf16 v[128:143], v[60:63], v[152:155], v[128:143]
    v_exp_f32 v104, v104
    v_exp_f32 v105, v105
    v_exp_f32 v106, v106
    v_smfmac_f32_32x32x32_bf16 v[176:191], v[64:67], v[96:103], v2
    s_waitcnt lgkmcnt(0)
    v_exp_f32 v107, v107
    v_exp_f32 v108, v108
    v_exp_f32 v109, v109
    v_exp_f32 v110, v110
    v_exp_f32 v111, v111
    v_exp_f32 v112, v112
    v_exp_f32 v113, v113
    v_smfmac_f32_32x32x32_bf16 v[176:191], v[68:71], v[104:111], v2
    ds_read_b128 v[64:67], v5 offset:14208
    v_exp_f32 v114, v114
    v_exp_f32 v115, v115
    v_exp_f32 v116, v116
    v_mfma_f32_32x32x4_2b_bf16 v[80:111], v[20:21], v[156:157], 0 cbsz:1 abid:0
    v_exp_f32 v117, v117
    v_exp_f32 v118, v118
    v_exp_f32 v119, v119
    v_exp_f32 v120, v120
    v_exp_f32 v121, v121
    v_exp_f32 v122, v122
    v_exp_f32 v123, v123
    v_exp_f32 v124, v124
    v_smfmac_f32_32x32x32_bf16 v[160:175], v[72:75], v[112:119], v2
    ds_read_b128 v[68:71], v5 offset:14816
    v_exp_f32 v125, v125
    v_exp_f32 v126, v126
    v_exp_f32 v127, v127
    v_exp_f32 v128, v128
    v_exp_f32 v129, v129
    v_smfmac_f32_32x32x32_bf16 v[160:175], v[76:79], v[120:127], v2
    ds_read_b128 v[60:63], v3 offset:15232
    v_exp_f32 v130, v130
    v_exp_f32 v131, v131
    v_exp_f32 v132, v132
    v_mfma_f32_32x32x16_bf16 v[80:95], v[56:59], v[148:151], v[80:95]
    v_exp_f32 v133, v133
    v_exp_f32 v134, v134
    v_exp_f32 v135, v135
    v_mfma_f32_32x32x16_bf16 v[96:111], v[56:59], v[152:155], v[96:111]
    v_exp_f32 v136, v136
    v_exp_f32 v137, v137
    v_exp_f32 v138, v138
    v_smfmac_f32_32x32x32_bf16 v[176:191], v[72:75], v[128:135], v2
    s_waitcnt lgkmcnt(0)
    v_exp_f32 v139, v139
    v_exp_f32 v140, v140
    v_exp_f32 v141, v141
    v_exp_f32 v142, v142
    v_exp_f32 v143, v143
    v_exp_f32 v80, v80
    v_exp_f32 v81, v81
    v_smfmac_f32_32x32x32_bf16 v[176:191], v[76:79], v[136:143], v2
    ds_read_b128 v[72:75], v5 offset:15424
    v_exp_f32 v82, v82
    v_exp_f32 v83, v83
    v_exp_f32 v84, v84
    v_mfma_f32_32x32x4_2b_bf16 v[112:143], v[20:21], v[156:157], 0 cbsz:1 abid:1
    v_exp_f32 v85, v85
    v_exp_f32 v86, v86
    v_exp_f32 v87, v87
    v_exp_f32 v88, v88
    v_exp_f32 v89, v89
    v_exp_f32 v90, v90
    v_exp_f32 v91, v91
    v_exp_f32 v92, v92
    v_smfmac_f32_32x32x32_bf16 v[160:175], v[64:67], v[80:87], v2
    ds_read_b128 v[76:79], v5 offset:16032
    v_exp_f32 v93, v93
    v_exp_f32 v94, v94
    v_exp_f32 v95, v95
    v_exp_f32 v96, v96
    v_exp_f32 v97, v97
    v_smfmac_f32_32x32x32_bf16 v[160:175], v[68:71], v[88:95], v2
    v_exp_f32 v98, v98
    v_exp_f32 v99, v99
    v_exp_f32 v100, v100
    v_mfma_f32_32x32x16_bf16 v[112:127], v[60:63], v[148:151], v[112:127]
    v_exp_f32 v101, v101
    v_exp_f32 v102, v102
    v_exp_f32 v103, v103
    v_mfma_f32_32x32x16_bf16 v[128:143], v[60:63], v[152:155], v[128:143]
    v_exp_f32 v104, v104
    v_exp_f32 v105, v105
    v_exp_f32 v106, v106
    v_smfmac_f32_32x32x32_bf16 v[176:191], v[64:67], v[96:103], v2
    s_waitcnt lgkmcnt(0)
    v_exp_f32 v107, v107
    v_exp_f32 v108, v108
    v_exp_f32 v109, v109
    v_exp_f32 v110, v110
    v_exp_f32 v111, v111
    v_exp_f32 v112, v112
    v_exp_f32 v113, v113
    v_smfmac_f32_32x32x32_bf16 v[176:191], v[68:71], v[104:111], v2
    v_exp_f32 v114, v114
    v_exp_f32 v115, v115
    v_exp_f32 v116, v116
    v_exp_f32 v117, v117
    v_exp_f32 v118, v118
    v_exp_f32 v119, v119
    v_exp_f32 v120, v120
    v_exp_f32 v121, v121
    v_exp_f32 v122, v122
    v_exp_f32 v123, v123
    v_exp_f32 v124, v124
    v_smfmac_f32_32x32x32_bf16 v[160:175], v[72:75], v[112:119], v2
    v_exp_f32 v125, v125
    v_exp_f32 v126, v126
    v_exp_f32 v127, v127
    v_exp_f32 v128, v128
    v_exp_f32 v129, v129
    v_smfmac_f32_32x32x32_bf16 v[160:175], v[76:79], v[120:127], v2
    v_exp_f32 v130, v130
    v_exp_f32 v131, v131
    v_exp_f32 v132, v132
    v_exp_f32 v133, v133
    v_exp_f32 v134, v134
    v_exp_f32 v135, v135
    v_exp_f32 v136, v136
    v_exp_f32 v137, v137
    v_exp_f32 v138, v138
    v_smfmac_f32_32x32x32_bf16 v[176:191], v[72:75], v[128:135], v2
    s_waitcnt lgkmcnt(0)
    v_exp_f32 v139, v139
    v_exp_f32 v140, v140
    v_exp_f32 v141, v141
    v_exp_f32 v142, v142
    v_exp_f32 v143, v143
    s_nop 1
    v_smfmac_f32_32x32x32_bf16 v[176:191], v[76:79], v[136:143], v2
    s_setprio 3
    s_barrier
    v_rcp_f32 v6, v169
    s_nop 0
    v_mul_f32 v160, v160, v6
    v_mul_f32 v161, v161, v6
    v_mul_f32 v162, v162, v6
    v_mul_f32 v163, v163, v6
    v_mul_f32 v164, v164, v6
    v_mul_f32 v165, v165, v6
    v_mul_f32 v166, v166, v6
    v_mul_f32 v167, v167, v6
    v_mul_f32 v168, v168, v6
    v_cvt_pk_bf16_f32 v204, v160, v161
    v_cvt_pk_bf16_f32 v205, v162, v163
    v_cvt_pk_bf16_f32 v206, v164, v165
    v_rcp_f32 v7, v185
    v_cvt_pk_bf16_f32 v207, v166, v167
    v_cmp_ne_u32 vcc, 0, v23
    s_cbranch_vccnz L_pub11
    buffer_store_dwordx4 v[204:207], v144, s[60:63], s27 offen offset:0 sc0 sc1
    v_mul_f32 v176, v176, v7
    v_mul_f32 v177, v177, v7
    v_mul_f32 v178, v178, v7
    v_mul_f32 v179, v179, v7
    v_mul_f32 v180, v180, v7
    v_mul_f32 v181, v181, v7
    v_mul_f32 v182, v182, v7
    v_mul_f32 v183, v183, v7
    v_mul_f32 v184, v184, v7
    v_cvt_pk_bf16_f32 v208, v168, v176
    v_cvt_pk_bf16_f32 v209, v177, v178
    v_cvt_pk_bf16_f32 v210, v179, v180
    v_cvt_pk_bf16_f32 v211, v181, v182
    buffer_store_dwordx4 v[208:211], v144, s[60:63], s27 offen offset:256 sc0 sc1
    v_cvt_pk_bf16_f32 v212, v183, v184
    buffer_store_dword v212, v145, s[60:63], s28 offen offset:1024 sc0 sc1
    s_branch L_pub21
L_pub11:
    buffer_store_dwordx4 v[204:207], v144, s[60:63], s27 offen offset:0
    v_mul_f32 v176, v176, v7
    v_mul_f32 v177, v177, v7
    v_mul_f32 v178, v178, v7
    v_mul_f32 v179, v179, v7
    v_mul_f32 v180, v180, v7
    v_mul_f32 v181, v181, v7
    v_mul_f32 v182, v182, v7
    v_mul_f32 v183, v183, v7
    v_mul_f32 v184, v184, v7
    v_cvt_pk_bf16_f32 v208, v168, v176
    v_cvt_pk_bf16_f32 v209, v177, v178
    v_cvt_pk_bf16_f32 v210, v179, v180
    v_cvt_pk_bf16_f32 v211, v181, v182
    buffer_store_dwordx4 v[208:211], v144, s[60:63], s27 offen offset:256
    v_cvt_pk_bf16_f32 v212, v183, v184
    buffer_store_dword v212, v145, s[60:63], s28 offen offset:1024
L_pub21:
    buffer_load_dwordx4 v[24:27], v1, s[60:63], s16 offen sc0 sc1
    buffer_load_dwordx4 v[28:31], v1, s[60:63], s17 offen sc0 sc1
    buffer_load_dwordx4 v[32:35], v1, s[60:63], s18 offen sc0 sc1
    buffer_load_dwordx4 v[36:39], v1, s[60:63], s19 offen sc0 sc1
    buffer_load_dwordx4 v[40:43], v1, s[60:63], s20 offen sc0 sc1
    buffer_load_dwordx4 v[44:47], v1, s[60:63], s21 offen sc0 sc1
    buffer_load_dwordx4 v[48:51], v1, s[60:63], s22 offen sc0 sc1
    ds_write_b128 v201, v[204:207] offset:8192
    ds_write_b128 v201, v[208:211] offset:8448
    ds_write_b32 v202, v212 offset:1024
    s_lshl_b32 s9, s8, 10
    s_add_u32 s9, s9, 12288
    v_add_u32 v8, s9, v1
    v_xor_b32 v9, 0x400, v8
    v_xor_b32 v10, 0x800, v8
    v_xor_b32 v11, 0xc00, v8
    v_lshrrev_b32 v6, 4, v0
    v_and_b32 v7, 15, v0
    v_mul_u32_u24 v22, 0x900, v7
    v_lshl_add_u32 v23, v6, 3, v22
    v_lshl_add_u32 v22, v6, 4, v22
    v_lshlrev_b32 v6, 11, v6
    v_lshl_add_u32 v6, v7, 2, v6
    s_lshl_b32 s9, s8, 8
    s_add_u32 s9, s9, 77824
    v_add_u32 v52, s9, v6
    v_xor_b32 v53, 0x100, v52
    v_xor_b32 v54, 0x200, v52
    v_xor_b32 v55, 0x300, v52
    v_add_u32 v16, 0x400, v52
    v_add_u32 v17, 0x400, v53
    v_add_u32 v18, 0x400, v54
    v_add_u32 v19, 0x400, v55
    v_add_u32 v21, 86016, v1
    v_add_u32 v216, s30, v1
    v_add_u32 v217, s31, v1
    v_add_u32 v218, s32, v1
    v_add_u32 v219, s33, v1
    v_add_u32 v220, s34, v1
    v_add_u32 v221, s35, v1
    v_add_u32 v222, s36, v1
    s_mov_b32 s15, 500000
L_cle:
    s_waitcnt vmcnt(0)
    v_max3_u32 v6, v24, v25, v26
    v_max3_u32 v7, v27, v28, v29
    v_max3_u32 v6, v6, v30, v31
    v_max3_u32 v7, v7, v32, v33
    v_max3_u32 v6, v6, v34, v35
    v_max3_u32 v7, v7, v36, v37
    v_max3_u32 v6, v6, v38, v39
    v_max3_u32 v7, v7, v40, v41
    v_max3_u32 v6, v6, v42, v43
    v_max3_u32 v7, v7, v44, v45
    v_max3_u32 v6, v6, v46, v47
    v_max3_u32 v7, v7, v48, v49
    v_max3_u32 v6, v6, v50, v51
    v_max_u32 v7, v7, v6
    v_cmp_eq_u32 vcc, -1, v7
    s_cbranch_vccz L_clde
    s_sub_u32 s15, s15, 1
    s_cbranch_scc1 L_clde
    buffer_load_dwordx4 v[24:27], v1, s[60:63], s16 offen sc0 sc1
    buffer_load_dwordx4 v[28:31], v1, s[60:63], s17 offen sc0 sc1
    buffer_load_dwordx4 v[32:35], v1, s[60:63], s18 offen sc0 sc1
    buffer_load_dwordx4 v[36:39], v1, s[60:63], s19 offen sc0 sc1
    buffer_load_dwordx4 v[40:43], v1, s[60:63], s20 offen sc0 sc1
    buffer_load_dwordx4 v[44:47], v1, s[60:63], s21 offen sc0 sc1
    buffer_load_dwordx4 v[48:51], v1, s[60:63], s22 offen sc0 sc1
    s_branch L_cle
L_clde:
    ds_write_b128 v216, v[24:27]
    ds_write_b128 v217, v[28:31]
    ds_write_b128 v218, v[32:35]
    ds_write_b128 v219, v[36:39]
    ds_write_b128 v220, v[40:43]
    ds_write_b128 v221, v[44:47]
    ds_write_b128 v222, v[48:51]
    s_waitcnt lgkmcnt(0)
    s_barrier
L_fin:
L_end:
    s_endpgm
L_late:
    s_setprio 0
    s_mov_b32 s58, 663552
    s_mov_b32 s59, 0x20000
    s_mul_i32 s9, s4, 4194304
    s_add_u32 s60, s40, s9
    s_addc_u32 s61, s41, 0
    s_mov_b32 s62, 3211264
    s_mov_b32 s63, 0x20000
    s_mov_b32 s64, s36
    s_mov_b32 s65, s37
    s_mov_b32 s66, 4718592
    s_mov_b32 s67, 0x20000
    s_mov_b32 s68, s38
    s_mov_b32 s69, s39
    s_mov_b32 s70, 256
    s_mov_b32 s71, 0x20000
    v_and_b32 v160, 7, v0
    v_lshlrev_b32 v160, 9, v160
    s_cmp_lg_u32 s3, 7
    s_cbranch_scc1 L_nov0
    s_mov_b32 s9, 155648
    buffer_load_dword v161, v160, s[60:63], s9 offen sc0 sc1
L_nov0:
    s_mov_b32 s50, 663552
    s_mov_b32 s51, 0x20000
    s_lshl_b32 s9, s8, 6
    s_mul_i32 s10, s5, 288
    v_mov_b32 v16, 0x480
    v_add_u32 v13, s9, v0
    v_mul_u32_u24 v14, 0xe39, v13
    v_lshrrev_b32 v14, 16, v14
    v_mul_u32_u24 v15, 18, v14
    v_sub_u32 v13, v13, v15
    v_lshlrev_b32 v13, 4, v13
    v_bfe_u32 v15, v14, 3, 1
    v_bfe_u32 v17, v14, 2, 1
    v_and_b32 v14, 19, v14
    v_lshl_add_u32 v14, v15, 2, v14
    v_lshl_add_u32 v14, v17, 3, v14
    v_mad_u32_u24 v13, v14, v16, v13
    v_add_u32 v10, s10, v13
    s_add_u32 s9, s9, 192
    v_add_u32 v13, s9, v0
    v_mul_u32_u24 v14, 0xe39, v13
    v_lshrrev_b32 v14, 16, v14
    v_mul_u32_u24 v15, 18, v14
    v_sub_u32 v13, v13, v15
    v_lshlrev_b32 v13, 4, v13
    v_bfe_u32 v15, v14, 3, 1
    v_bfe_u32 v17, v14, 2, 1
    v_and_b32 v14, 19, v14
    v_lshl_add_u32 v14, v15, 2, v14
    v_lshl_add_u32 v14, v17, 3, v14
    v_mad_u32_u24 v13, v14, v16, v13
    v_add_u32 v11, s10, v13
    s_add_u32 s9, s9, 192
    v_add_u32 v13, s9, v0
    v_mul_u32_u24 v14, 0xe39, v13
    v_lshrrev_b32 v14, 16, v14
    v_mul_u32_u24 v15, 18, v14
    v_sub_u32 v13, v13, v15
    v_lshlrev_b32 v13, 4, v13
    v_bfe_u32 v15, v14, 3, 1
    v_bfe_u32 v17, v14, 2, 1
    v_and_b32 v14, 19, v14
    v_lshl_add_u32 v14, v15, 2, v14
    v_lshl_add_u32 v14, v17, 3, v14
    v_mad_u32_u24 v13, v14, v16, v13
    v_add_u32 v12, s10, v13
    s_xor_b32 s13, s13, 4
    s_add_u32 s100, s14, s13
    s_mul_i32 s100, s100, 9216
    s_mul_i32 s79, s13, 9216
    s_add_u32 s79, s79, 90112
    s_movk_i32 s72, 1024
    s_movk_i32 s73, 128
    v_and_b32 v13, 15, v0
    v_lshrrev_b32 v16, 4, v0
    v_bfe_u32 v17, v0, 1, 3
    v_xor_b32 v17, v16, v17
    v_lshlrev_b32 v17, 4, v17
    v_and_b32 v18, 7, v0
    v_lshl_add_u32 v17, v18, 7, v17
    v_bfe_u32 v18, v0, 3, 1
    v_mul_u32_u24 v18, 0x2400, v18
    s_lshr_b32 s9, s5, 1
    s_lshl_b32 s9, s9, 1
    s_add_u32 s9, s9, s76
    s_mul_i32 s10, s9, 18432
    s_add_u32 s10, s10, 90112
    v_add3_u32 v14, v17, v18, s10
    v_xor_b32 v15, 64, v14
    v_bfe_u32 v17, v0, 2, 2
    v_lshl_add_u32 v17, v16, 3, v17
    v_mul_u32_u24 v17, 48, v17
    v_and_b32 v18, 3, v0
    v_lshlrev_b32 v18, 3, v18
    s_cmp_eq_u32 s77, 0
    s_cselect_b64 vcc, -1, 0
    v_mov_b32 v19, 32
    v_cndmask_b32 v18, v19, v18, vcc
    v_add_u32 v17, 62464, v17
    v_add_u32 v17, v17, v18
    v_lshrrev_b32 v19, 5, v0
    v_lshlrev_b32 v19, 9, v19
    v_lshl_add_u32 v19, v13, 4, v19
    v_bfe_u32 v18, v0, 4, 1
    v_lshl_add_u32 v28, v18, 3, v19
    v_lshlrev_b32 v29, 2, v13
    s_mul_i32 s80, s7, 4736
    s_mov_b32 s81, s9
    s_bitcmp1_b32 s5, 0
    s_cselect_b32 s83, 5, 0
    s_add_u32 s101, s83, s6
    s_cmp_ge_u32 s101, 9
    s_cselect_b32 s9, 9, 0
    s_sub_u32 s101, s101, s9
    s_mul_i32 s101, s101, s73
    s_mul_i32 s83, s83, s72
    s_mul_i32 s74, s72, 9
    s_mul_i32 s75, s73, 9
    s_add_u32 m0, s79, s83
    s_add_u32 s12, s100, s101
    buffer_load_dwordx4 v8, s[44:47], s12 offen lds
    s_add_u32 s101, s101, s73
    s_cmp_eq_u32 s101, s75
    s_cselect_b32 s101, 0, s101
    s_add_u32 s83, s83, s72
    s_cmp_eq_u32 s83, s74
    s_cselect_b32 s83, 0, s83
    s_add_u32 m0, s79, s83
    s_add_u32 s12, s100, s101
    buffer_load_dwordx4 v8, s[44:47], s12 offen lds
    s_add_u32 s101, s101, s73
    s_cmp_eq_u32 s101, s75
    s_cselect_b32 s101, 0, s101
    s_add_u32 s83, s83, s72
    s_cmp_eq_u32 s83, s74
    s_cselect_b32 s83, 0, s83
    s_add_u32 m0, s79, s83
    s_add_u32 s12, s100, s101
    buffer_load_dwordx4 v8, s[44:47], s12 offen lds
    s_add_u32 s101, s101, s73
    s_cmp_eq_u32 s101, s75
    s_cselect_b32 s101, 0, s101
    s_add_u32 s83, s83, s72
    s_cmp_eq_u32 s83, s74
    s_cselect_b32 s83, 0, s83
    s_add_u32 m0, s79, s83
    s_add_u32 s12, s100, s101
    buffer_load_dwordx4 v8, s[44:47], s12 offen lds
    s_add_u32 s101, s101, s73
    s_cmp_eq_u32 s101, s75
    s_cselect_b32 s101, 0, s101
    s_add_u32 s83, s83, s72
    s_cmp_eq_u32 s83, s74
    s_cselect_b32 s83, 0, s83
    s_add_u32 m0, s79, s83
    s_add_u32 s12, s100, s101
    buffer_load_dwordx4 v8, s[44:47], s12 offen lds
    s_add_u32 s101, s101, s73
    s_cmp_eq_u32 s101, s75
    s_cselect_b32 s101, 0, s101
    s_add_u32 s83, s83, s72
    s_cmp_eq_u32 s83, s74
    s_cselect_b32 s83, 0, s83
    s_add_u32 m0, s79, s83
    s_add_u32 s12, s100, s101
    buffer_load_dwordx4 v8, s[44:47], s12 offen lds
    s_add_u32 s101, s101, s73
    s_cmp_eq_u32 s101, s75
    s_cselect_b32 s101, 0, s101
    s_add_u32 s83, s83, s72
    s_cmp_eq_u32 s83, s74
    s_cselect_b32 s83, 0, s83
    s_add_u32 m0, s79, s83
    s_add_u32 s12, s100, s101
    buffer_load_dwordx4 v8, s[44:47], s12 offen lds
    s_add_u32 s101, s101, s73
    s_cmp_eq_u32 s101, s75
    s_cselect_b32 s101, 0, s101
    s_add_u32 s83, s83, s72
    s_cmp_eq_u32 s83, s74
    s_cselect_b32 s83, 0, s83
    s_add_u32 m0, s79, s83
    s_add_u32 s12, s100, s101
    buffer_load_dwordx4 v8, s[44:47], s12 offen lds
    s_add_u32 s101, s101, s73
    s_cmp_eq_u32 s101, s75
    s_cselect_b32 s101, 0, s101
    s_add_u32 s83, s83, s72
    s_cmp_eq_u32 s83, s74
    s_cselect_b32 s83, 0, s83
    s_add_u32 m0, s79, s83
    s_add_u32 s12, s100, s101
    buffer_load_dwordx4 v8, s[44:47], s12 offen lds
    s_add_u32 s9, s42, L_table-L_pc
    s_addc_u32 s10, s43, 0
    v_mov_b32 v7, s10
    v_add_co_u32 v6, vcc, s9, v1
    s_nop 1
    v_addc_co_u32 v7, vcc, 0, v7, vcc
    s_nop 0
    global_load_dwordx4 v[20:23], v[6:7], off
    s_setprio 1
    s_waitcnt vmcnt(10)
    s_barrier
    s_bitcmp1_b32 s5, 0
    s_cbranch_scc1 L_vproj
    ds_read_b128 v[40:43], v14 offset:0
    ds_read_b64_tr_b16 v[44:45], v17 offset:0
    ds_read_b64_tr_b16 v[46:47], v17 offset:192
    ds_read_b128 v[48:51], v15 offset:0
    ds_read_b64_tr_b16 v[52:53], v17 offset:1536
    ds_read_b64_tr_b16 v[54:55], v17 offset:1728
    ds_read_b128 v[56:59], v14 offset:1024
    ds_read_b64_tr_b16 v[60:61], v17 offset:3072
    ds_read_b64_tr_b16 v[62:63], v17 offset:3264
    ds_read_b128 v[64:67], v15 offset:1024
    ds_read_b64_tr_b16 v[68:69], v17 offset:4608
    ds_read_b64_tr_b16 v[70:71], v17 offset:4800
    ds_read_b128 v[72:75], v14 offset:2048
    ds_read_b64_tr_b16 v[76:77], v17 offset:6144
    ds_read_b64_tr_b16 v[78:79], v17 offset:6336
    s_waitcnt lgkmcnt(12)
    v_mfma_f32_16x16x32_bf16 v[32:35], v[44:47], v[40:43], 0
    ds_read_b128 v[40:43], v15 offset:2048
    ds_read_b64_tr_b16 v[44:45], v17 offset:7680
    ds_read_b64_tr_b16 v[46:47], v17 offset:7872
    s_waitcnt lgkmcnt(12)
    v_mfma_f32_16x16x32_bf16 v[32:35], v[52:55], v[48:51], v[32:35]
    ds_read_b128 v[48:51], v14 offset:3072
    ds_read_b64_tr_b16 v[52:53], v17 offset:9216
    ds_read_b64_tr_b16 v[54:55], v17 offset:9408
    s_waitcnt lgkmcnt(12)
    v_mfma_f32_16x16x32_bf16 v[32:35], v[60:63], v[56:59], v[32:35]
    ds_read_b128 v[56:59], v15 offset:3072
    ds_read_b64_tr_b16 v[60:61], v17 offset:10752
    ds_read_b64_tr_b16 v[62:63], v17 offset:10944
    s_waitcnt lgkmcnt(12)
    v_mfma_f32_16x16x32_bf16 v[32:35], v[68:71], v[64:67], v[32:35]
    ds_read_b128 v[64:67], v14 offset:4096
    ds_read_b64_tr_b16 v[68:69], v17 offset:12288
    ds_read_b64_tr_b16 v[70:71], v17 offset:12480
    s_waitcnt lgkmcnt(12)
    v_mfma_f32_16x16x32_bf16 v[32:35], v[76:79], v[72:75], v[32:35]
    ds_read_b128 v[72:75], v15 offset:4096
    ds_read_b64_tr_b16 v[76:77], v17 offset:13824
    ds_read_b64_tr_b16 v[78:79], v17 offset:14016
    s_waitcnt lgkmcnt(12)
    v_mfma_f32_16x16x32_bf16 v[32:35], v[44:47], v[40:43], v[32:35]
    ds_read_b128 v[40:43], v14 offset:5120
    ds_read_b64_tr_b16 v[44:45], v17 offset:15360
    ds_read_b64_tr_b16 v[46:47], v17 offset:15552
    s_waitcnt lgkmcnt(12)
    v_mfma_f32_16x16x32_bf16 v[32:35], v[52:55], v[48:51], v[32:35]
    ds_read_b128 v[48:51], v15 offset:5120
    ds_read_b64_tr_b16 v[52:53], v17 offset:16896
    ds_read_b64_tr_b16 v[54:55], v17 offset:17088
    s_waitcnt lgkmcnt(12)
    v_mfma_f32_16x16x32_bf16 v[32:35], v[60:63], v[56:59], v[32:35]
    ds_read_b128 v[56:59], v14 offset:6144
    ds_read_b64_tr_b16 v[60:61], v17 offset:18432
    ds_read_b64_tr_b16 v[62:63], v17 offset:18624
    s_waitcnt lgkmcnt(12)
    v_mfma_f32_16x16x32_bf16 v[32:35], v[68:71], v[64:67], v[32:35]
    ds_read_b128 v[64:67], v15 offset:6144
    ds_read_b64_tr_b16 v[68:69], v17 offset:19968
    ds_read_b64_tr_b16 v[70:71], v17 offset:20160
    s_waitcnt lgkmcnt(12)
    v_mfma_f32_16x16x32_bf16 v[32:35], v[76:79], v[72:75], v[32:35]
    ds_read_b128 v[72:75], v14 offset:7168
    ds_read_b64_tr_b16 v[76:77], v17 offset:21504
    ds_read_b64_tr_b16 v[78:79], v17 offset:21696
    s_waitcnt lgkmcnt(12)
    v_mfma_f32_16x16x32_bf16 v[32:35], v[44:47], v[40:43], v[32:35]
    ds_read_b128 v[40:43], v15 offset:7168
    ds_read_b64_tr_b16 v[44:45], v17 offset:23040
    ds_read_b64_tr_b16 v[46:47], v17 offset:23232
    s_waitcnt lgkmcnt(12)
    v_mfma_f32_16x16x32_bf16 v[32:35], v[52:55], v[48:51], v[32:35]
    ds_read_b128 v[48:51], v14 offset:8192
    ds_read_b64_tr_b16 v[52:53], v17 offset:24576
    ds_read_b64_tr_b16 v[54:55], v17 offset:24768
    s_waitcnt lgkmcnt(12)
    v_mfma_f32_16x16x32_bf16 v[32:35], v[60:63], v[56:59], v[32:35]
    ds_read_b128 v[56:59], v15 offset:8192
    ds_read_b64_tr_b16 v[60:61], v17 offset:26112
    ds_read_b64_tr_b16 v[62:63], v17 offset:26304
    s_waitcnt lgkmcnt(12)
    v_mfma_f32_16x16x32_bf16 v[32:35], v[68:71], v[64:67], v[32:35]
    s_waitcnt lgkmcnt(9)
    v_mfma_f32_16x16x32_bf16 v[32:35], v[76:79], v[72:75], v[32:35]
    s_waitcnt lgkmcnt(6)
    v_mfma_f32_16x16x32_bf16 v[32:35], v[44:47], v[40:43], v[32:35]
    s_waitcnt lgkmcnt(3)
    v_mfma_f32_16x16x32_bf16 v[32:35], v[52:55], v[48:51], v[32:35]
    s_waitcnt vmcnt(0)
    s_waitcnt lgkmcnt(0)
    v_mfma_f32_16x16x32_bf16 v[32:35], v[60:63], v[56:59], v[32:35]
    s_lshr_b32 s9, s81, 1
    s_lshl_b32 s9, s9, 10
    s_lshl_b32 s10, s76, 8
    s_add_u32 s9, s9, s10
    s_add_u32 s9, s9, s80
    s_lshl_b32 s10, s81, 6
    s_add_u32 s10, s10, s80
    s_add_u32 s10, s10, 2048
    s_mov_b32 s11, 0x3eae1a93
    v_mul_f32 v32, s11, v32
    v_mul_f32 v33, s11, v33
    v_mul_f32 v34, s11, v34
    v_mul_f32 v35, s11, v35
    v_cvt_pk_bf16_f32 v32, v32, v33
    v_cvt_pk_bf16_f32 v33, v34, v35
    s_lshl_b32 s12, s7, 2
    s_add_u32 s12, s12, s81
    s_lshl_b32 s12, s12, 2
    s_add_u32 s12, s12, 151552
    v_dot2_f32_bf16 v36, v32, v32, 0
    s_cmp_eq_u32 s77, 0
    s_cbranch_scc0 L_krem
    buffer_store_dwordx2 v[32:33], v28, s[60:63], s9 offen sc1
    v_dot2_f32_bf16 v36, v33, v33, v36
    s_nop 2
    v_mov_b32 v37, v36
    s_nop 1
    v_permlane16_swap_b32 v36, v37
    s_nop 1
    v_add_f32 v36, v36, v37
    s_nop 0
    v_mov_b32 v37, v36
    s_nop 1
    v_permlane32_swap_b32 v36, v37
    s_nop 1
    v_add_f32 v36, v36, v37
    s_branch L_knorm
L_krem:
    s_mov_b64 exec, 0xffff
    buffer_store_dword v32, v29, s[60:63], s10 offen sc1
    s_mov_b64 exec, -1
    s_add_u32 s12, s12, 512
L_knorm:
    s_nop 1
    s_nop 1
    v_max_f32_dpp v36, v36, v36 row_ror:8 row_mask:0xf bank_mask:0xf
    s_nop 1
    v_max_f32_dpp v36, v36, v36 row_ror:4 row_mask:0xf bank_mask:0xf
    s_nop 1
    v_max_f32_dpp v36, v36, v36 row_ror:2 row_mask:0xf bank_mask:0xf
    s_nop 1
    v_max_f32_dpp v36, v36, v36 row_ror:1 row_mask:0xf bank_mask:0xf
    v_mov_b32 v37, 0
    s_mov_b64 exec, 1
    buffer_store_dword v36, v37, s[60:63], s12 offen sc1
    s_mov_b64 exec, -1
    s_branch L_kvdone
L_vproj:
    ds_read_b128 v[40:43], v14 offset:0
    ds_read_b64_tr_b16 v[44:45], v17 offset:0
    ds_read_b64_tr_b16 v[46:47], v17 offset:192
    ds_read_b128 v[48:51], v15 offset:0
    ds_read_b64_tr_b16 v[52:53], v17 offset:1536
    ds_read_b64_tr_b16 v[54:55], v17 offset:1728
    ds_read_b128 v[56:59], v14 offset:1024
    ds_read_b64_tr_b16 v[60:61], v17 offset:3072
    ds_read_b64_tr_b16 v[62:63], v17 offset:3264
    ds_read_b128 v[64:67], v15 offset:1024
    ds_read_b64_tr_b16 v[68:69], v17 offset:4608
    ds_read_b64_tr_b16 v[70:71], v17 offset:4800
    ds_read_b128 v[72:75], v14 offset:2048
    ds_read_b64_tr_b16 v[76:77], v17 offset:6144
    ds_read_b64_tr_b16 v[78:79], v17 offset:6336
    s_waitcnt lgkmcnt(12)
    v_mfma_f32_16x16x32_bf16 v[32:35], v[40:43], v[44:47], 0
    ds_read_b128 v[40:43], v15 offset:2048
    ds_read_b64_tr_b16 v[44:45], v17 offset:7680
    ds_read_b64_tr_b16 v[46:47], v17 offset:7872
    s_waitcnt lgkmcnt(12)
    v_mfma_f32_16x16x32_bf16 v[32:35], v[48:51], v[52:55], v[32:35]
    ds_read_b128 v[48:51], v14 offset:3072
    ds_read_b64_tr_b16 v[52:53], v17 offset:9216
    ds_read_b64_tr_b16 v[54:55], v17 offset:9408
    s_waitcnt lgkmcnt(12)
    v_mfma_f32_16x16x32_bf16 v[32:35], v[56:59], v[60:63], v[32:35]
    ds_read_b128 v[56:59], v15 offset:3072
    ds_read_b64_tr_b16 v[60:61], v17 offset:10752
    ds_read_b64_tr_b16 v[62:63], v17 offset:10944
    s_waitcnt lgkmcnt(12)
    v_mfma_f32_16x16x32_bf16 v[32:35], v[64:67], v[68:71], v[32:35]
    ds_read_b128 v[64:67], v14 offset:4096
    ds_read_b64_tr_b16 v[68:69], v17 offset:12288
    ds_read_b64_tr_b16 v[70:71], v17 offset:12480
    s_waitcnt lgkmcnt(12)
    v_mfma_f32_16x16x32_bf16 v[32:35], v[72:75], v[76:79], v[32:35]
    ds_read_b128 v[72:75], v15 offset:4096
    ds_read_b64_tr_b16 v[76:77], v17 offset:13824
    ds_read_b64_tr_b16 v[78:79], v17 offset:14016
    s_waitcnt lgkmcnt(12)
    v_mfma_f32_16x16x32_bf16 v[32:35], v[40:43], v[44:47], v[32:35]
    ds_read_b128 v[40:43], v14 offset:5120
    ds_read_b64_tr_b16 v[44:45], v17 offset:15360
    ds_read_b64_tr_b16 v[46:47], v17 offset:15552
    s_waitcnt lgkmcnt(12)
    v_mfma_f32_16x16x32_bf16 v[32:35], v[48:51], v[52:55], v[32:35]
    ds_read_b128 v[48:51], v15 offset:5120
    ds_read_b64_tr_b16 v[52:53], v17 offset:16896
    ds_read_b64_tr_b16 v[54:55], v17 offset:17088
    s_waitcnt lgkmcnt(12)
    v_mfma_f32_16x16x32_bf16 v[32:35], v[56:59], v[60:63], v[32:35]
    ds_read_b128 v[56:59], v14 offset:6144
    ds_read_b64_tr_b16 v[60:61], v17 offset:18432
    ds_read_b64_tr_b16 v[62:63], v17 offset:18624
    s_waitcnt lgkmcnt(12)
    v_mfma_f32_16x16x32_bf16 v[32:35], v[64:67], v[68:71], v[32:35]
    ds_read_b128 v[64:67], v15 offset:6144
    ds_read_b64_tr_b16 v[68:69], v17 offset:19968
    ds_read_b64_tr_b16 v[70:71], v17 offset:20160
    s_waitcnt lgkmcnt(12)
    v_mfma_f32_16x16x32_bf16 v[32:35], v[72:75], v[76:79], v[32:35]
    ds_read_b128 v[72:75], v14 offset:7168
    ds_read_b64_tr_b16 v[76:77], v17 offset:21504
    ds_read_b64_tr_b16 v[78:79], v17 offset:21696
    s_waitcnt lgkmcnt(12)
    v_mfma_f32_16x16x32_bf16 v[32:35], v[40:43], v[44:47], v[32:35]
    ds_read_b128 v[40:43], v15 offset:7168
    ds_read_b64_tr_b16 v[44:45], v17 offset:23040
    ds_read_b64_tr_b16 v[46:47], v17 offset:23232
    s_waitcnt lgkmcnt(12)
    v_mfma_f32_16x16x32_bf16 v[32:35], v[48:51], v[52:55], v[32:35]
    ds_read_b128 v[48:51], v14 offset:8192
    ds_read_b64_tr_b16 v[52:53], v17 offset:24576
    ds_read_b64_tr_b16 v[54:55], v17 offset:24768
    s_waitcnt lgkmcnt(12)
    v_mfma_f32_16x16x32_bf16 v[32:35], v[56:59], v[60:63], v[32:35]
    ds_read_b128 v[56:59], v15 offset:8192
    ds_read_b64_tr_b16 v[60:61], v17 offset:26112
    ds_read_b64_tr_b16 v[62:63], v17 offset:26304
    s_waitcnt lgkmcnt(12)
    v_mfma_f32_16x16x32_bf16 v[32:35], v[64:67], v[68:71], v[32:35]
    s_waitcnt lgkmcnt(9)
    v_mfma_f32_16x16x32_bf16 v[32:35], v[72:75], v[76:79], v[32:35]
    s_waitcnt lgkmcnt(6)
    v_mfma_f32_16x16x32_bf16 v[32:35], v[40:43], v[44:47], v[32:35]
    s_waitcnt lgkmcnt(3)
    v_mfma_f32_16x16x32_bf16 v[32:35], v[48:51], v[52:55], v[32:35]
    s_waitcnt vmcnt(0)
    s_waitcnt lgkmcnt(0)
    v_mfma_f32_16x16x32_bf16 v[32:35], v[56:59], v[60:63], v[32:35]
    s_mul_i32 s9, s81, 608
    s_add_u32 s9, s9, s80
    s_add_u32 s9, s9, 2304
    v_cmp_eq_u32 vcc, 2, v13
    v_cmp_eq_u32 s[42:43], 3, v13
    v_mov_b32 v30, 0x3f803f80
    s_nop 0
    s_cmp_eq_u32 s77, 0
    v_cvt_pk_bf16_f32 v32, v32, v33
    v_cvt_pk_bf16_f32 v33, v34, v35
    s_cbranch_scc0 L_vrem
    buffer_store_dwordx2 v[32:33], v21, s[60:63], s9 offen sc1
    s_branch L_vdone
L_vrem:
    v_cndmask_b32 v32, v32, v30, vcc
    v_cndmask_b32 v33, v33, v30, vcc
    v_cndmask_b32 v32, v32, 0, s[42:43]
    v_cndmask_b32 v33, v33, 0, s[42:43]
    s_mov_b32 exec_lo, 0x000f000f
    s_mov_b32 exec_hi, 0x000f000f
    buffer_store_dwordx2 v[32:33], v22, s[60:63], s9 offen sc1
    s_mov_b64 exec, -1
L_vdone:
L_kvdone:
    s_getreg_b32 s29, hwreg(HW_REG_XCC_ID, 0, 4)
    s_cmp_lg_u32 s3, 4
    s_cbranch_scc1 L_noxid
    s_lshl_b32 s9, s7, 2
    s_add_u32 s9, s9, s5
    s_lshl_b32 s9, s9, 2
    s_add_u32 s9, s9, 152576
    v_mov_b32 v38, s29
    v_mov_b32 v39, 0
    s_mov_b64 exec, 1
    buffer_store_dword v38, v39, s[60:63], s9 offen sc1
    s_mov_b64 exec, -1
L_noxid:
    v_mov_b32 v5, v20
    s_lshl_b32 s72, s8, 10
    s_mul_i32 s74, s6, 73728
    s_add_u32 s74, s74, 147456
    s_cmp_ge_u32 s74, 663552
    s_cselect_b32 s9, 663552, 0
    s_sub_u32 s74, s74, s9
    s_cmp_lt_u32 s8, 3
    s_cselect_b64 vcc, -1, 0
    v_mov_b32 v100, 1
    v_mov_b32 v101, 0
    s_barrier
    s_cbranch_vccz L_wq5
    s_add_u32 m0, s72, 36864
    s_add_u32 s9, s74, 36864
    buffer_load_dwordx4 v10, s[48:51], s74 offen lds
    s_add_u32 m0, s72, 39936
    s_nop 0
    buffer_load_dwordx4 v11, s[48:51], s74 offen lds
    s_add_u32 m0, s72, 43008
    s_cmp_ge_u32 s9, 663552
    buffer_load_dwordx4 v12, s[48:51], s74 offen lds
    s_cselect_b32 s10, 663552, 0
    s_sub_u32 s74, s9, s10
L_wq5:
    s_cbranch_vccz L_wq6
    s_add_u32 m0, s72, 46080
    s_add_u32 s9, s74, 36864
    buffer_load_dwordx4 v10, s[48:51], s74 offen lds
    s_add_u32 m0, s72, 49152
    s_nop 0
    buffer_load_dwordx4 v11, s[48:51], s74 offen lds
    s_add_u32 m0, s72, 52224
    s_cmp_ge_u32 s9, 663552
    buffer_load_dwordx4 v12, s[48:51], s74 offen lds
    s_cselect_b32 s10, 663552, 0
    s_sub_u32 s74, s9, s10
L_wq6:
    s_barrier
    s_cbranch_vccz L_wq7
    s_add_u32 m0, s72, 62464
    s_add_u32 s9, s74, 36864
    buffer_load_dwordx4 v10, s[48:51], s74 offen lds
    s_add_u32 m0, s72, 65536
    s_nop 0
    buffer_load_dwordx4 v11, s[48:51], s74 offen lds
    s_add_u32 m0, s72, 68608
    s_cmp_ge_u32 s9, 663552
    buffer_load_dwordx4 v12, s[48:51], s74 offen lds
    s_cselect_b32 s10, 663552, 0
    s_sub_u32 s74, s9, s10
L_wq7:
    s_cbranch_vccz L_wq8
    s_add_u32 m0, s72, 71680
    s_add_u32 s9, s74, 36864
    buffer_load_dwordx4 v10, s[48:51], s74 offen lds
    s_add_u32 m0, s72, 74752
    s_nop 0
    buffer_load_dwordx4 v11, s[48:51], s74 offen lds
    s_add_u32 m0, s72, 77824
    s_cmp_ge_u32 s9, 663552
    buffer_load_dwordx4 v12, s[48:51], s74 offen lds
    s_cselect_b32 s10, 663552, 0
    s_sub_u32 s74, s9, s10
L_wq8:
    s_cbranch_vccz L_wq9
    s_add_u32 m0, s72, 80896
    s_add_u32 s9, s74, 36864
    buffer_load_dwordx4 v10, s[48:51], s74 offen lds
    s_add_u32 m0, s72, 83968
    s_nop 0
    buffer_load_dwordx4 v11, s[48:51], s74 offen lds
    s_add_u32 m0, s72, 87040
    s_cmp_ge_u32 s9, 663552
    buffer_load_dwordx4 v12, s[48:51], s74 offen lds
    s_cselect_b32 s10, 663552, 0
    s_sub_u32 s74, s9, s10
L_wq9:
    s_cbranch_vccnz L_l1
    s_waitcnt vmcnt(0)
L_l1:
    s_waitcnt vmcnt(9)
    s_barrier
    s_cbranch_vccnz L_nosig
    s_setprio 3
    v_add_u32 v161, 16, v161
    s_bfe_u32 s9, s2, 0x20001
    s_lshl_b32 s9, s9, 1
    s_and_b32 s10, s6, 1
    s_add_u32 s9, s9, s10
    s_lshl_b32 s9, s9, 9
    s_add_u32 s9, s9, 155648
    s_mov_b64 exec, 1
    buffer_atomic_add v100, v101, s[60:63], s9 offen sc1
    s_mov_b64 exec, -1
    s_setprio 1
L_nosig:
    s_cbranch_vccz L_wq10
    s_add_u32 m0, s72, 90112
    s_add_u32 s9, s74, 36864
    buffer_load_dwordx4 v10, s[48:51], s74 offen lds
    s_add_u32 m0, s72, 93184
    s_nop 0
    buffer_load_dwordx4 v11, s[48:51], s74 offen lds
    s_add_u32 m0, s72, 96256
    s_cmp_ge_u32 s9, 663552
    buffer_load_dwordx4 v12, s[48:51], s74 offen lds
    s_cselect_b32 s10, 663552, 0
    s_sub_u32 s74, s9, s10
L_wq10:
    s_cbranch_vccz L_wq11
    s_add_u32 m0, s72, 99328
    s_add_u32 s9, s74, 36864
    buffer_load_dwordx4 v10, s[48:51], s74 offen lds
    s_add_u32 m0, s72, 102400
    s_nop 0
    buffer_load_dwordx4 v11, s[48:51], s74 offen lds
    s_add_u32 m0, s72, 105472
    s_cmp_ge_u32 s9, 663552
    buffer_load_dwordx4 v12, s[48:51], s74 offen lds
    s_cselect_b32 s10, 663552, 0
    s_sub_u32 s74, s9, s10
L_wq11:
    s_cbranch_vccz L_wq12
    s_add_u32 m0, s72, 108544
    s_add_u32 s9, s74, 36864
    buffer_load_dwordx4 v10, s[48:51], s74 offen lds
    s_add_u32 m0, s72, 111616
    s_nop 0
    buffer_load_dwordx4 v11, s[48:51], s74 offen lds
    s_add_u32 m0, s72, 114688
    s_cmp_ge_u32 s9, 663552
    buffer_load_dwordx4 v12, s[48:51], s74 offen lds
    s_cselect_b32 s10, 663552, 0
    s_sub_u32 s74, s9, s10
L_wq12:
    s_waitcnt vmcnt(12)
    v_mov_b32 v150, 10256
    v_mov_b32 v152, 0
    v_mov_b32 v153, 0
    v_mov_b32 v154, 0
    v_mov_b32 v155, 0
    v_mov_b32 v151, 0
    ds_write_b128 v150, v[152:155]
    s_waitcnt lgkmcnt(0)
    s_barrier
    s_cbranch_vccz L_wq13
    s_add_u32 m0, s72, 117760
    s_add_u32 s9, s74, 36864
    buffer_load_dwordx4 v10, s[48:51], s74 offen lds
    s_add_u32 m0, s72, 120832
    s_nop 0
    buffer_load_dwordx4 v11, s[48:51], s74 offen lds
    s_add_u32 m0, s72, 123904
    s_cmp_ge_u32 s9, 663552
    buffer_load_dwordx4 v12, s[48:51], s74 offen lds
    s_cselect_b32 s10, 663552, 0
    s_sub_u32 s74, s9, s10
L_wq13:
    s_cbranch_vccz L_wq14
    s_add_u32 m0, s72, 126976
    s_add_u32 s9, s74, 36864
    buffer_load_dwordx4 v10, s[48:51], s74 offen lds
    s_add_u32 m0, s72, 130048
    s_nop 0
    buffer_load_dwordx4 v11, s[48:51], s74 offen lds
    s_add_u32 m0, s72, 133120
    s_cmp_ge_u32 s9, 663552
    buffer_load_dwordx4 v12, s[48:51], s74 offen lds
    s_cselect_b32 s10, 663552, 0
    s_sub_u32 s74, s9, s10
L_wq14:
    s_lshl_b32 s81, s7, 2
    s_add_u32 s81, s81, s5
    s_lshl_b32 s81, s81, 2
    s_add_u32 s81, s81, s8
    s_mul_i32 s16, s81, 3641
    s_lshr_b32 s16, s16, 16
    s_mul_i32 s19, s16, 18
    s_sub_u32 s19, s81, s19
    s_mul_i32 s21, s16, 7282
    s_lshr_b32 s21, s21, 16
    s_mul_i32 s17, s21, 9
    s_sub_u32 s17, s16, s17
    s_mul_i32 s22, s21, 288
    s_lshr_b32 s23, s17, 1
    s_lshl_b32 s23, s23, 6
    s_add_u32 s22, s22, s23
    s_and_b32 s23, s17, 1
    s_lshl_b32 s23, s23, 3
    s_add_u32 s22, s22, s23
    s_cmp_eq_u32 s17, 8
    s_cselect_b32 s23, 3, 4
    v_bfe_u32 v200, v0, 2, 2
    v_lshlrev_b32 v200, s23, v200
    v_and_b32 v201, 3, v0
    v_lshl_add_u32 v200, v201, 1, v200
    v_add_u32 v200, s22, v200
    s_cmp_ge_u32 s19, 16
    s_cbranch_scc1 L_wok1_0
    s_lshr_b32 s23, s19, 2
    s_add_u32 s23, s23, s21
    s_and_b32 s23, s23, 3
    s_mul_i32 s22, s23, 165888
    s_and_b32 s23, s19, 1
    s_mul_i32 s23, s23, 82944
    s_add_u32 s22, s22, s23
    s_bfe_u32 s23, s19, 0x10001
    s_mul_i32 s23, s23, 41472
    s_add_u32 s22, s22, s23
    v_lshrrev_b32 v201, 5, v0
    v_bfe_u32 v202, v0, 4, 1
    v_mul_u32_u24 v203, 4608, v201
    v_add_u32 v203, v200, v203
    v_mul_u32_u24 v204, 3456, v201
    v_sub_u32 v204, 18432, v204
    v_mul_u32_u24 v204, v202, v204
    v_add_u32 v208, v203, v204
    v_mul_u32_u24 v204, 19584, v202
    v_add_u32 v204, 1152, v204
    v_add_u32 v209, v203, v204
    v_mul_u32_u24 v204, 19584, v202
    v_add_u32 v204, 2304, v204
    v_add_u32 v210, v203, v204
    v_mul_u32_u24 v204, 19584, v202
    v_add_u32 v204, 3456, v204
    v_add_u32 v211, v203, v204
    v_mul_u32_u24 v204, 14976, v202
    v_add_u32 v204, 9216, v204
    v_add_u32 v212, v203, v204
    v_mul_u32_u24 v204, 19584, v202
    v_add_u32 v204, 10368, v204
    v_add_u32 v213, v203, v204
    v_mul_u32_u24 v204, 19584, v202
    v_add_u32 v204, 11520, v204
    v_add_u32 v214, v203, v204
    v_mul_u32_u24 v204, 19584, v202
    v_add_u32 v204, 12672, v204
    v_add_u32 v215, v203, v204
    s_branch L_wold_0
L_wok1_0:
    s_and_b32 s22, s19, 1
    s_mul_i32 s22, s22, 41472
    v_lshrrev_b32 v201, 4, v0
    v_add_u32 v201, s21, v201
    v_and_b32 v201, 3, v201
    v_mul_u32_u24 v201, 165888, v201
    v_add_u32 v203, v200, v201
    v_add_u32 v208, 33408, v203
    v_add_u32 v209, 39168, v203
    v_add_u32 v210, 38016, v203
    v_add_u32 v211, 40320, v203
    v_add_u32 v212, 116352, v203
    v_add_u32 v213, 122112, v203
    v_add_u32 v214, 120960, v203
    v_add_u32 v215, 123264, v203
L_wold_0:
    s_mov_b32 s30, s22
    v_mov_b32 v192, -1
    v_mov_b32 v193, -1
    v_mov_b32 v194, -1
    v_mov_b32 v195, -1
    s_lshl_b32 s32, s7, 2
    s_add_u32 s32, s32, s5
    s_mul_i32 s32, s32, 18432
    s_add_u32 s32, s32, 851968
    s_lshl_b32 s33, s8, 12
    s_add_u32 s33, s33, s32
    s_lshl_b32 s34, s76, 10
    s_add_u32 s34, s34, s32
    s_add_u32 s34, s34, 16384
    s_waitcnt vmcnt(12)
    s_barrier
    s_cbranch_vccz L_wq15
    s_add_u32 m0, s72, 136192
    s_add_u32 s9, s74, 36864
    buffer_load_dwordx4 v10, s[48:51], s74 offen lds
    s_add_u32 m0, s72, 139264
    s_nop 0
    buffer_load_dwordx4 v11, s[48:51], s74 offen lds
    s_add_u32 m0, s72, 142336
    s_cmp_ge_u32 s9, 663552
    buffer_load_dwordx4 v12, s[48:51], s74 offen lds
    s_cselect_b32 s10, 663552, 0
    s_sub_u32 s74, s9, s10
L_wq15:
    s_cbranch_vccz L_wq16
    s_add_u32 m0, s72, 145408
    s_add_u32 s9, s74, 36864
    buffer_load_dwordx4 v10, s[48:51], s74 offen lds
    s_add_u32 m0, s72, 148480
    s_nop 0
    buffer_load_dwordx4 v11, s[48:51], s74 offen lds
    s_add_u32 m0, s72, 151552
    s_cmp_ge_u32 s9, 663552
    buffer_load_dwordx4 v12, s[48:51], s74 offen lds
    s_cselect_b32 s10, 663552, 0
    s_sub_u32 s74, s9, s10
L_wq16:
    s_cmp_ge_u32 s81, 136
    s_cselect_b32 s16, 0, 512
    s_add_u32 s81, s81, s16
    s_mul_i32 s16, s81, 3641
    s_lshr_b32 s16, s16, 16
    s_mul_i32 s19, s16, 18
    s_sub_u32 s19, s81, s19
    s_mul_i32 s21, s16, 7282
    s_lshr_b32 s21, s21, 16
    s_mul_i32 s17, s21, 9
    s_sub_u32 s17, s16, s17
    s_mul_i32 s22, s21, 288
    s_lshr_b32 s23, s17, 1
    s_lshl_b32 s23, s23, 6
    s_add_u32 s22, s22, s23
    s_and_b32 s23, s17, 1
    s_lshl_b32 s23, s23, 3
    s_add_u32 s22, s22, s23
    s_cmp_eq_u32 s17, 8
    s_cselect_b32 s23, 3, 4
    v_bfe_u32 v200, v0, 2, 2
    v_lshlrev_b32 v200, s23, v200
    v_and_b32 v201, 3, v0
    v_lshl_add_u32 v200, v201, 1, v200
    v_add_u32 v200, s22, v200
    s_cmp_ge_u32 s19, 16
    s_cbranch_scc1 L_wok1_1
    s_lshr_b32 s23, s19, 2
    s_add_u32 s23, s23, s21
    s_and_b32 s23, s23, 3
    s_mul_i32 s22, s23, 165888
    s_and_b32 s23, s19, 1
    s_mul_i32 s23, s23, 82944
    s_add_u32 s22, s22, s23
    s_bfe_u32 s23, s19, 0x10001
    s_mul_i32 s23, s23, 41472
    s_add_u32 s22, s22, s23
    v_lshrrev_b32 v201, 5, v0
    v_bfe_u32 v202, v0, 4, 1
    v_mul_u32_u24 v203, 4608, v201
    v_add_u32 v203, v200, v203
    v_mul_u32_u24 v204, 3456, v201
    v_sub_u32 v204, 18432, v204
    v_mul_u32_u24 v204, v202, v204
    v_add_u32 v216, v203, v204
    v_mul_u32_u24 v204, 19584, v202
    v_add_u32 v204, 1152, v204
    v_add_u32 v217, v203, v204
    v_mul_u32_u24 v204, 19584, v202
    v_add_u32 v204, 2304, v204
    v_add_u32 v218, v203, v204
    v_mul_u32_u24 v204, 19584, v202
    v_add_u32 v204, 3456, v204
    v_add_u32 v219, v203, v204
    v_mul_u32_u24 v204, 14976, v202
    v_add_u32 v204, 9216, v204
    v_add_u32 v220, v203, v204
    v_mul_u32_u24 v204, 19584, v202
    v_add_u32 v204, 10368, v204
    v_add_u32 v221, v203, v204
    v_mul_u32_u24 v204, 19584, v202
    v_add_u32 v204, 11520, v204
    v_add_u32 v222, v203, v204
    v_mul_u32_u24 v204, 19584, v202
    v_add_u32 v204, 12672, v204
    v_add_u32 v223, v203, v204
    s_branch L_wold_1
L_wok1_1:
    s_and_b32 s22, s19, 1
    s_mul_i32 s22, s22, 41472
    v_lshrrev_b32 v201, 4, v0
    v_add_u32 v201, s21, v201
    v_and_b32 v201, 3, v201
    v_mul_u32_u24 v201, 165888, v201
    v_add_u32 v203, v200, v201
    v_add_u32 v216, 33408, v203
    v_add_u32 v217, 39168, v203
    v_add_u32 v218, 38016, v203
    v_add_u32 v219, 40320, v203
    v_add_u32 v220, 116352, v203
    v_add_u32 v221, 122112, v203
    v_add_u32 v222, 120960, v203
    v_add_u32 v223, 123264, v203
L_wold_1:
    s_mov_b32 s31, s22
    s_cmp_lt_u32 s8, 3
    s_cselect_b64 vcc, -1, 0
    s_waitcnt vmcnt(12)
    s_barrier
    s_cbranch_vccz L_wq17
    s_add_u32 m0, s72, 154624
    s_add_u32 s9, s74, 36864
    buffer_load_dwordx4 v10, s[48:51], s74 offen lds
    s_add_u32 m0, s72, 157696
    s_nop 0
    buffer_load_dwordx4 v11, s[48:51], s74 offen lds
    s_add_u32 m0, s72, 160768
    s_cmp_ge_u32 s9, 663552
    buffer_load_dwordx4 v12, s[48:51], s74 offen lds
    s_cselect_b32 s10, 663552, 0
    s_sub_u32 s74, s9, s10
L_wq17:
    s_cbranch_vccz L_wq18
    s_add_u32 m0, s72, 46080
    s_add_u32 s9, s74, 36864
    buffer_load_dwordx4 v10, s[48:51], s74 offen lds
    s_add_u32 m0, s72, 49152
    s_nop 0
    buffer_load_dwordx4 v11, s[48:51], s74 offen lds
    s_add_u32 m0, s72, 52224
    s_cmp_ge_u32 s9, 663552
    buffer_load_dwordx4 v12, s[48:51], s74 offen lds
    s_cselect_b32 s10, 663552, 0
    s_sub_u32 s74, s9, s10
L_wq18:
    s_and_b32 s9, s6, 3
    s_mul_i32 s80, s9, 37888
    s_add_u32 s80, s80, s72
    v_lshlrev_b32 v153, 3, v0
    s_mov_b32 s13, 151552
    s_lshl_b32 s14, s4, 7
    s_waitcnt vmcnt(12)
    s_cbranch_vccnz L_try1
    s_mov_b32 s9, 155648
    buffer_load_dword v152, v160, s[60:63], s9 offen sc0 sc1
L_try1:
    s_barrier
    s_waitcnt vmcnt(6)
    s_cbranch_vccnz L_try0
    s_waitcnt vmcnt(0)
    v_cmp_ne_u32 s[16:17], v152, v161
    s_cmp_eq_u64 s[16:17], 0
    s_cselect_b32 s16, 1, 0
    v_mov_b32 v152, s16
    ds_write_b32 v150, v152
    s_waitcnt lgkmcnt(0)
L_try0:
    s_barrier
    ds_read_b32 v152, v150
    s_waitcnt lgkmcnt(0)
    v_cmp_eq_u32 vcc, 0, v152
    s_cbranch_vccnz L_notyet
    s_cmp_lg_u32 s3, 7
    s_cbranch_scc1 L_kna
    buffer_load_dwordx2 v[154:155], v153, s[60:63], s13 offen sc1
    buffer_load_dwordx2 v[156:157], v153, s[60:63], s13 offen offset:512 sc1
L_kna:
    s_add_u32 m0, s72, 12288
    s_add_u32 s9, s80, 4096
    buffer_load_dwordx4 v1, s[60:63], s80 offen sc1 lds
    s_cmp_ge_u32 s9, 151552
    s_cselect_b32 s10, 151552, 0
    s_sub_u32 s80, s9, s10
    s_add_u32 m0, s72, 16384
    s_add_u32 s9, s80, 4096
    buffer_load_dwordx4 v1, s[60:63], s80 offen sc1 lds
    s_cmp_ge_u32 s9, 151552
    s_cselect_b32 s10, 151552, 0
    s_sub_u32 s80, s9, s10
    s_add_u32 m0, s72, 20480
    s_add_u32 s9, s80, 4096
    buffer_load_dwordx4 v1, s[60:63], s80 offen sc1 lds
    s_cmp_ge_u32 s9, 151552
    s_cselect_b32 s10, 151552, 0
    s_sub_u32 s80, s9, s10
    s_add_u32 m0, s72, 24576
    s_add_u32 s9, s80, 4096
    buffer_load_dwordx4 v1, s[60:63], s80 offen sc1 lds
    s_cmp_ge_u32 s9, 151552
    s_cselect_b32 s10, 151552, 0
    s_sub_u32 s80, s9, s10
    s_cmp_eq_u32 s3, 7
    s_cbranch_scc1 L_knb
    s_waitcnt vmcnt(4)
L_knb:
    s_barrier
    s_add_u32 m0, s72, 28672
    s_add_u32 s9, s80, 4096
    buffer_load_dwordx4 v1, s[60:63], s80 offen sc1 lds
    s_cmp_ge_u32 s9, 151552
    s_cselect_b32 s10, 151552, 0
    s_sub_u32 s80, s9, s10
    s_add_u32 m0, s72, 32768
    s_add_u32 s9, s80, 4096
    buffer_load_dwordx4 v1, s[60:63], s80 offen sc1 lds
    s_cmp_ge_u32 s9, 151552
    s_cselect_b32 s10, 151552, 0
    s_sub_u32 s80, s9, s10
    s_branch L_first
L_notyet:
    s_waitcnt vmcnt(0)
    s_barrier
    s_mov_b32 s15, 8000000
    s_cmp_lg_u32 s3, 7
    s_cbranch_scc1 L_relay
    s_mov_b32 s15, 500000
    s_mov_b32 s9, 155648
L_poll1:
    buffer_load_dword v152, v160, s[60:63], s9 offen sc0 sc1
    s_cmp_gt_u32 s15, 499996
    s_cbranch_scc1 L_pf
    s_cmp_lg_u32 s15, 499936
    s_cbranch_scc1 L_ps
    s_mov_b64 exec, 1
    buffer_atomic_add v100, v101, s[68:71], s14 offen sc1
    s_mov_b64 exec, -1
L_ps:
    buffer_load_dwordx3 v[162:164], v151, s[68:71], s14 offen sc0 sc1
    s_waitcnt vmcnt(0)
    v_lshrrev_b32 v162, 7, v162
    v_or3_b32 v162, v162, v163, v164
    v_cmp_ne_u32 vcc, 0, v162
    s_cbranch_vccnz L_poll1d
L_pf:
    s_sub_u32 s15, s15, 1
    s_cbranch_scc1 L_poll1d
    s_waitcnt vmcnt(0)
    v_cmp_ne_u32 vcc, v152, v161
    s_cbranch_vccnz L_poll1
L_poll1d:
    v_mov_b32 v152, 1
    ds_write_b32 v150, v152
    buffer_load_dwordx2 v[154:155], v153, s[60:63], s13 offen sc1
    buffer_load_dwordx2 v[156:157], v153, s[60:63], s13 offen offset:512 sc1
    s_branch L_flagok
L_relay:
    ds_read_b32 v152, v150
    s_sub_u32 s15, s15, 1
    s_cbranch_scc1 L_flagok
    s_waitcnt lgkmcnt(0)
    v_cmp_eq_u32 vcc, 0, v152
    s_cbranch_vccnz L_relay
L_flagok:
    s_add_u32 m0, s72, 12288
    s_add_u32 s9, s80, 4096
    buffer_load_dwordx4 v1, s[60:63], s80 offen sc1 lds
    s_cmp_ge_u32 s9, 151552
    s_cselect_b32 s10, 151552, 0
    s_sub_u32 s80, s9, s10
    s_add_u32 m0, s72, 16384
    s_add_u32 s9, s80, 4096
    buffer_load_dwordx4 v1, s[60:63], s80 offen sc1 lds
    s_cmp_ge_u32 s9, 151552
    s_cselect_b32 s10, 151552, 0
    s_sub_u32 s80, s9, s10
    s_add_u32 m0, s72, 20480
    s_add_u32 s9, s80, 4096
    buffer_load_dwordx4 v1, s[60:63], s80 offen sc1 lds
    s_cmp_ge_u32 s9, 151552
    s_cselect_b32 s10, 151552, 0
    s_sub_u32 s80, s9, s10
    s_add_u32 m0, s72, 24576
    s_add_u32 s9, s80, 4096
    buffer_load_dwordx4 v1, s[60:63], s80 offen sc1 lds
    s_cmp_ge_u32 s9, 151552
    s_cselect_b32 s10, 151552, 0
    s_sub_u32 s80, s9, s10
    s_add_u32 m0, s72, 28672
    s_add_u32 s9, s80, 4096
    buffer_load_dwordx4 v1, s[60:63], s80 offen sc1 lds
    s_cmp_ge_u32 s9, 151552
    s_cselect_b32 s10, 151552, 0
    s_sub_u32 s80, s9, s10
    s_add_u32 m0, s72, 32768
    s_add_u32 s9, s80, 4096
    buffer_load_dwordx4 v1, s[60:63], s80 offen sc1 lds
    s_cmp_ge_u32 s9, 151552
    s_cselect_b32 s10, 151552, 0
    s_sub_u32 s80, s9, s10
L_first:
    s_cmp_lg_u32 s3, 7
    s_cbranch_scc1 L_nokn
    s_waitcnt vmcnt(6)
    v_max_f32 v154, v154, v155
    v_max_f32 v156, v156, v157
    s_nop 1
    v_max_f32_dpp v154, v154, v154 row_ror:8 row_mask:0xf bank_mask:0xf
    s_nop 1
    v_max_f32_dpp v154, v154, v154 row_ror:4 row_mask:0xf bank_mask:0xf
    s_nop 1
    v_max_f32_dpp v154, v154, v154 row_ror:2 row_mask:0xf bank_mask:0xf
    s_nop 1
    v_max_f32_dpp v154, v154, v154 row_ror:1 row_mask:0xf bank_mask:0xf
    s_nop 1
    v_max_f32_dpp v156, v156, v156 row_ror:8 row_mask:0xf bank_mask:0xf
    s_nop 1
    v_max_f32_dpp v156, v156, v156 row_ror:4 row_mask:0xf bank_mask:0xf
    s_nop 1
    v_max_f32_dpp v156, v156, v156 row_ror:2 row_mask:0xf bank_mask:0xf
    s_nop 1
    v_max_f32_dpp v156, v156, v156 row_ror:1 row_mask:0xf bank_mask:0xf
    s_nop 0
    v_readlane_b32 s16, v154, 0
    v_readlane_b32 s20, v156, 0
    v_readlane_b32 s17, v154, 16
    v_readlane_b32 s21, v156, 16
    v_readlane_b32 s18, v154, 32
    v_readlane_b32 s22, v156, 32
    v_readlane_b32 s19, v154, 48
    v_readlane_b32 s23, v156, 48
    s_nop 1
    s_max_u32 s16, s16, s17
    s_max_u32 s18, s18, s19
    s_max_u32 s20, s20, s21
    s_max_u32 s22, s22, s23
    s_max_u32 s16, s16, s18
    s_max_u32 s20, s20, s22
    v_mov_b32 v154, s16
    v_add_f32 v154, s20, v154
    v_sqrt_f32 v154, v154
    v_mov_b32 v155, 10240
    ds_write_b32 v155, v154
L_nokn:
    s_waitcnt vmcnt(0) lgkmcnt(0)
    s_barrier
    s_add_u32 m0, s72, 36864
    s_add_u32 s9, s80, 4096
    buffer_load_dwordx4 v1, s[60:63], s80 offen sc1 lds
    s_cmp_ge_u32 s9, 151552
    s_cselect_b32 s10, 151552, 0
    s_sub_u32 s80, s9, s10
    s_add_u32 m0, s72, 40960
    s_add_u32 s9, s80, 4096
    buffer_load_dwordx4 v1, s[60:63], s80 offen sc1 lds
    s_cmp_ge_u32 s9, 151552
    s_cselect_b32 s10, 151552, 0
    s_sub_u32 s80, s9, s10
    s_add_u32 m0, s72, 45056
    s_add_u32 s9, s80, 4096
    buffer_load_dwordx4 v1, s[60:63], s80 offen sc1 lds
    s_cmp_ge_u32 s9, 151552
    s_cselect_b32 s10, 151552, 0
    s_sub_u32 s80, s9, s10
    s_add_u32 m0, s72, 49152
    s_add_u32 s9, s80, 4096
    buffer_load_dwordx4 v1, s[60:63], s80 offen sc1 lds
    s_cmp_ge_u32 s9, 151552
    s_cselect_b32 s10, 151552, 0
    s_sub_u32 s80, s9, s10
    s_add_u32 m0, s72, 53248
    s_add_u32 s9, s80, 4096
    buffer_load_dwordx4 v1, s[60:63], s80 offen sc1 lds
    s_cmp_ge_u32 s9, 151552
    s_cselect_b32 s10, 151552, 0
    s_sub_u32 s80, s9, s10
    s_add_u32 m0, s72, 57344
    s_add_u32 s9, s80, 4096
    buffer_load_dwordx4 v1, s[60:63], s80 offen sc1 lds
    s_cmp_ge_u32 s9, 151552
    s_cselect_b32 s10, 151552, 0
    s_sub_u32 s80, s9, s10
    s_add_u32 m0, s72, 61440
    s_add_u32 s9, s80, 4096
    buffer_load_dwordx4 v1, s[60:63], s80 offen sc1 lds
    s_cmp_ge_u32 s9, 151552
    s_cselect_b32 s10, 151552, 0
    s_sub_u32 s80, s9, s10
    s_add_u32 m0, s72, 65536
    s_add_u32 s9, s80, 4096
    buffer_load_dwordx4 v1, s[60:63], s80 offen sc1 lds
    s_cmp_ge_u32 s9, 151552
    s_cselect_b32 s10, 151552, 0
    s_sub_u32 s80, s9, s10
    s_add_u32 m0, s72, 69632
    s_add_u32 s9, s80, 4096
    buffer_load_dwordx4 v1, s[60:63], s80 offen sc1 lds
    s_cmp_ge_u32 s9, 151552
    s_cselect_b32 s10, 151552, 0
    s_sub_u32 s80, s9, s10
    s_add_u32 m0, s72, 73728
    s_add_u32 s9, s80, 4096
    buffer_load_dwordx4 v1, s[60:63], s80 offen sc1 lds
    s_cmp_ge_u32 s9, 151552
    s_cselect_b32 s10, 151552, 0
    s_sub_u32 s80, s9, s10
    s_add_u32 m0, s72, 77824
    s_add_u32 s9, s80, 4096
    buffer_load_dwordx4 v1, s[60:63], s80 offen sc1 lds
    s_cmp_ge_u32 s9, 151552
    s_cselect_b32 s10, 151552, 0
    s_sub_u32 s80, s9, s10
    s_add_u32 m0, s72, 81920
    s_add_u32 s9, s80, 4096
    buffer_load_dwordx4 v1, s[60:63], s80 offen sc1 lds
    s_cmp_ge_u32 s9, 151552
    s_cselect_b32 s10, 151552, 0
    s_sub_u32 s80, s9, s10
    s_add_u32 m0, s72, 86016
    s_add_u32 s9, s80, 4096
    buffer_load_dwordx4 v1, s[60:63], s80 offen sc1 lds
    s_cmp_ge_u32 s9, 151552
    s_cselect_b32 s10, 151552, 0
    s_sub_u32 s80, s9, s10
    s_add_u32 m0, s72, 90112
    s_add_u32 s9, s80, 4096
    buffer_load_dwordx4 v1, s[60:63], s80 offen sc1 lds
    s_cmp_ge_u32 s9, 151552
    s_cselect_b32 s10, 151552, 0
    s_sub_u32 s80, s9, s10
    s_add_u32 m0, s72, 94208
    s_add_u32 s9, s80, 4096
    buffer_load_dwordx4 v1, s[60:63], s80 offen sc1 lds
    s_cmp_ge_u32 s9, 151552
    s_cselect_b32 s10, 151552, 0
    s_sub_u32 s80, s9, s10
    s_add_u32 m0, s72, 98304
    s_add_u32 s9, s80, 4096
    buffer_load_dwordx4 v1, s[60:63], s80 offen sc1 lds
    s_cmp_ge_u32 s9, 151552
    s_cselect_b32 s10, 151552, 0
    s_sub_u32 s80, s9, s10
    s_add_u32 m0, s72, 102400
    s_add_u32 s9, s80, 4096
    buffer_load_dwordx4 v1, s[60:63], s80 offen sc1 lds
    s_cmp_ge_u32 s9, 151552
    s_cselect_b32 s10, 151552, 0
    s_sub_u32 s80, s9, s10
    s_add_u32 m0, s72, 106496
    s_add_u32 s9, s80, 4096
    buffer_load_dwordx4 v1, s[60:63], s80 offen sc1 lds
    s_cmp_ge_u32 s9, 151552
    s_cselect_b32 s10, 151552, 0
    s_sub_u32 s80, s9, s10
    s_add_u32 m0, s72, 110592
    s_add_u32 s9, s80, 4096
    buffer_load_dwordx4 v1, s[60:63], s80 offen sc1 lds
    s_cmp_ge_u32 s9, 151552
    s_cselect_b32 s10, 151552, 0
    s_sub_u32 s80, s9, s10
    s_add_u32 m0, s72, 114688
    s_add_u32 s9, s80, 4096
    buffer_load_dwordx4 v1, s[60:63], s80 offen sc1 lds
    s_cmp_ge_u32 s9, 151552
    s_cselect_b32 s10, 151552, 0
    s_sub_u32 s80, s9, s10
    s_add_u32 m0, s72, 118784
    s_add_u32 s9, s80, 4096
    buffer_load_dwordx4 v1, s[60:63], s80 offen sc1 lds
    s_cmp_ge_u32 s9, 151552
    s_cselect_b32 s10, 151552, 0
    s_sub_u32 s80, s9, s10
    s_add_u32 m0, s72, 122880
    s_add_u32 s9, s80, 4096
    buffer_load_dwordx4 v1, s[60:63], s80 offen sc1 lds
    s_cmp_ge_u32 s9, 151552
    s_cselect_b32 s10, 151552, 0
    s_sub_u32 s80, s9, s10
    s_add_u32 m0, s72, 126976
    s_add_u32 s9, s80, 4096
    buffer_load_dwordx4 v1, s[60:63], s80 offen sc1 lds
    s_cmp_ge_u32 s9, 151552
    s_cselect_b32 s10, 151552, 0
    s_sub_u32 s80, s9, s10
    s_add_u32 m0, s72, 131072
    s_add_u32 s9, s80, 4096
    buffer_load_dwordx4 v1, s[60:63], s80 offen sc1 lds
    s_cmp_ge_u32 s9, 151552
    s_cselect_b32 s10, 151552, 0
    s_sub_u32 s80, s9, s10
    s_add_u32 m0, s72, 135168
    s_add_u32 s9, s80, 4096
    buffer_load_dwordx4 v1, s[60:63], s80 offen sc1 lds
    s_cmp_ge_u32 s9, 151552
    s_cselect_b32 s10, 151552, 0
    s_sub_u32 s80, s9, s10
    s_add_u32 m0, s72, 139264
    s_add_u32 s9, s80, 4096
    buffer_load_dwordx4 v1, s[60:63], s80 offen sc1 lds
    s_cmp_ge_u32 s9, 151552
    s_cselect_b32 s10, 151552, 0
    s_sub_u32 s80, s9, s10
    s_add_u32 m0, s72, 143360
    s_add_u32 s9, s80, 4096
    buffer_load_dwordx4 v1, s[60:63], s80 offen sc1 lds
    s_cmp_ge_u32 s9, 151552
    s_cselect_b32 s10, 151552, 0
    s_sub_u32 s80, s9, s10
    s_add_u32 m0, s72, 147456
    s_add_u32 s9, s80, 4096
    buffer_load_dwordx4 v1, s[60:63], s80 offen sc1 lds
    s_cmp_ge_u32 s9, 151552
    s_cselect_b32 s10, 151552, 0
    s_sub_u32 s80, s9, s10
    s_add_u32 m0, s72, 151552
    s_add_u32 s9, s80, 4096
    buffer_load_dwordx4 v1, s[60:63], s80 offen sc1 lds
    s_cmp_ge_u32 s9, 151552
    s_cselect_b32 s10, 151552, 0
    s_sub_u32 s80, s9, s10
    s_add_u32 m0, s72, 155648
    s_add_u32 s9, s80, 4096
    buffer_load_dwordx4 v1, s[60:63], s80 offen sc1 lds
    s_cmp_ge_u32 s9, 151552
    s_cselect_b32 s10, 151552, 0
    s_sub_u32 s80, s9, s10
    s_add_u32 m0, s72, 159744
    s_add_u32 s9, s80, 4096
    buffer_load_dwordx4 v1, s[60:63], s80 offen sc1 lds
    s_cmp_ge_u32 s9, 151552
    s_cselect_b32 s10, 151552, 0
    s_sub_u32 s80, s9, s10
    s_setprio 2
    s_mov_b32 s82, 0
    s_waitcnt vmcnt(0)
    s_barrier
    s_cmp_lg_u32 s3, 7
    s_cbranch_scc1 L_nosaw
    s_cmp_ge_u32 s2, 8
    s_cbranch_scc1 L_nosaw
    s_mov_b64 exec, 1
    buffer_atomic_add v100, v101, s[68:71], s14 offen offset:8 sc1
    s_mov_b64 exec, -1
L_nosaw:
    buffer_load_ushort v224, v208, s[56:59], s30 offen
    buffer_load_ushort v225, v209, s[56:59], s30 offen
    buffer_load_ushort v226, v210, s[56:59], s30 offen
    buffer_load_ushort v227, v211, s[56:59], s30 offen
    buffer_load_ushort v228, v212, s[56:59], s30 offen
    buffer_load_ushort v229, v213, s[56:59], s30 offen
    buffer_load_ushort v230, v214, s[56:59], s30 offen
    buffer_load_ushort v231, v215, s[56:59], s30 offen
    s_cmp_lt_u32 s81, 512
    s_cbranch_scc1 L_nowo2
    buffer_load_ushort v232, v216, s[56:59], s31 offen
    buffer_load_ushort v233, v217, s[56:59], s31 offen
    buffer_load_ushort v234, v218, s[56:59], s31 offen
    buffer_load_ushort v235, v219, s[56:59], s31 offen
    buffer_load_ushort v236, v220, s[56:59], s31 offen
    buffer_load_ushort v237, v221, s[56:59], s31 offen
    buffer_load_ushort v238, v222, s[56:59], s31 offen
    buffer_load_ushort v239, v223, s[56:59], s31 offen
L_nowo2:
    s_lshl_b32 s9, s7, 4
    s_add_u32 s9, s9, 152576
    v_and_b32 v8, 3, v0
    v_lshlrev_b32 v8, 2, v8
    buffer_load_dword v9, v8, s[60:63], s9 offen sc1
    buffer_store_dwordx4 v[192:195], v1, s[60:63], s33 offen offset:0 sc0 sc1
    buffer_store_dwordx4 v[192:195], v1, s[60:63], s33 offen offset:1024 sc0 sc1
    buffer_store_dwordx4 v[192:195], v1, s[60:63], s33 offen offset:2048 sc0 sc1
    buffer_store_dwordx4 v[192:195], v1, s[60:63], s33 offen offset:3072 sc0 sc1
    buffer_store_dwordx4 v[192:195], v1, s[60:63], s34 offen sc0 sc1
    s_waitcnt vmcnt(5)
    s_cmp_ge_u32 s81, 512
    s_cbranch_scc0 L_wo3
    s_lshl_b32 s22, s81, 10
    s_add_u32 s22, s22, 163840
    v_lshl_or_b32 v244, v233, 16, v232
    v_lshl_or_b32 v245, v235, 16, v234
    v_lshl_or_b32 v246, v237, 16, v236
    v_lshl_or_b32 v247, v239, 16, v238
    buffer_store_dwordx4 v[244:247], v1, s[60:63], s22 offen sc1
    s_sub_u32 s81, s81, 512
L_wo3:
    s_lshl_b32 s22, s81, 10
    s_add_u32 s22, s22, 163840
    v_lshl_or_b32 v240, v225, 16, v224
    v_lshl_or_b32 v241, v227, 16, v226
    v_lshl_or_b32 v242, v229, 16, v228
    v_lshl_or_b32 v243, v231, 16, v230
    buffer_store_dwordx4 v[240:243], v1, s[60:63], s22 offen sc1
    v_mov_b32 v10, 10264
    v_cmp_ne_u32 vcc, s29, v9
    s_cmp_eq_u64 vcc, 0
    s_cselect_b32 s26, 1, 0
    v_mov_b32 v11, s26
    ds_write_b32 v10, v11
    s_waitcnt lgkmcnt(0)
    v_mov_b32 v12, 10260
    v_mov_b32 v13, 1
    v_mov_b32 v15, 0
    s_lshl_b32 s9, s4, 7
    s_mov_b64 exec, 1
    s_waitcnt vmcnt(0)
    ds_add_rtn_u32 v14, v12, v13
    s_waitcnt lgkmcnt(0)
    v_cmp_eq_u32 vcc, 3, v14
    s_cbranch_vccz L_jsl
    buffer_atomic_add v13, v15, s[68:71], s9 offen offset:4 sc1
L_jsl:
    s_mov_b64 exec, -1
    s_setprio 0
    s_mul_i32 s78, s7, 73728
    s_add_u32 s78, s78, 851968
    s_mul_i32 s25, s5, 18432
    s_add_u32 s25, s25, s78
    s_add_u32 s27, s25, 8192
    s_add_u32 s28, s25, 16384
    s_lshl_b32 s23, s82, 13
    s_lshl_b32 s24, s82, 10
    s_add_u32 s9, s8, 0
    s_mul_i32 s10, s9, 7282
    s_lshr_b32 s10, s10, 16
    s_mul_i32 s11, s10, 9
    s_sub_u32 s11, s9, s11
    s_add_u32 s10, s10, 1
    s_lshl_b32 s9, s11, 10
    s_add_u32 s9, s9, s23
    s_add_u32 s12, s24, 16384
    s_lshl_b32 s30, s10, 14
    s_add_u32 s30, s30, s9
    s_lshl_b32 s16, s10, 11
    s_add_u32 s16, s16, s24
    s_add_u32 s16, s16, 65536
    s_cmp_eq_u32 s11, 8
    s_cselect_b32 s9, s12, s9
    s_cselect_b32 s30, s16, s30
    s_add_u32 s30, s30, 12288
    s_add_u32 s10, s10, s5
    s_and_b32 s10, s10, 3
    s_mul_i32 s10, s10, 18432
    s_add_u32 s9, s9, s10
    s_add_u32 s16, s9, s78
    s_add_u32 s9, s8, 4
    s_mul_i32 s10, s9, 7282
    s_lshr_b32 s10, s10, 16
    s_mul_i32 s11, s10, 9
    s_sub_u32 s11, s9, s11
    s_add_u32 s10, s10, 1
    s_lshl_b32 s9, s11, 10
    s_add_u32 s9, s9, s23
    s_add_u32 s12, s24, 16384
    s_lshl_b32 s31, s10, 14
    s_add_u32 s31, s31, s9
    s_lshl_b32 s17, s10, 11
    s_add_u32 s17, s17, s24
    s_add_u32 s17, s17, 65536
    s_cmp_eq_u32 s11, 8
    s_cselect_b32 s9, s12, s9
    s_cselect_b32 s31, s17, s31
    s_add_u32 s31, s31, 12288
    s_add_u32 s10, s10, s5
    s_and_b32 s10, s10, 3
    s_mul_i32 s10, s10, 18432
    s_add_u32 s9, s9, s10
    s_add_u32 s17, s9, s78
    s_add_u32 s9, s8, 8
    s_mul_i32 s10, s9, 7282
    s_lshr_b32 s10, s10, 16
    s_mul_i32 s11, s10, 9
    s_sub_u32 s11, s9, s11
    s_add_u32 s10, s10, 1
    s_lshl_b32 s9, s11, 10
    s_add_u32 s9, s9, s23
    s_add_u32 s12, s24, 16384
    s_lshl_b32 s32, s10, 14
    s_add_u32 s32, s32, s9
    s_lshl_b32 s18, s10, 11
    s_add_u32 s18, s18, s24
    s_add_u32 s18, s18, 65536
    s_cmp_eq_u32 s11, 8
    s_cselect_b32 s9, s12, s9
    s_cselect_b32 s32, s18, s32
    s_add_u32 s32, s32, 12288
    s_add_u32 s10, s10, s5
    s_and_b32 s10, s10, 3
    s_mul_i32 s10, s10, 18432
    s_add_u32 s9, s9, s10
    s_add_u32 s18, s9, s78
    s_add_u32 s9, s8, 12
    s_mul_i32 s10, s9, 7282
    s_lshr_b32 s10, s10, 16
    s_mul_i32 s11, s10, 9
    s_sub_u32 s11, s9, s11
    s_add_u32 s10, s10, 1
    s_lshl_b32 s9, s11, 10
    s_add_u32 s9, s9, s23
    s_add_u32 s12, s24, 16384
    s_lshl_b32 s33, s10, 14
    s_add_u32 s33, s33, s9
    s_lshl_b32 s19, s10, 11
    s_add_u32 s19, s19, s24
    s_add_u32 s19, s19, 65536
    s_cmp_eq_u32 s11, 8
    s_cselect_b32 s9, s12, s9
    s_cselect_b32 s33, s19, s33
    s_add_u32 s33, s33, 12288
    s_add_u32 s10, s10, s5
    s_and_b32 s10, s10, 3
    s_mul_i32 s10, s10, 18432
    s_add_u32 s9, s9, s10
    s_add_u32 s19, s9, s78
    s_add_u32 s9, s8, 16
    s_mul_i32 s10, s9, 7282
    s_lshr_b32 s10, s10, 16
    s_mul_i32 s11, s10, 9
    s_sub_u32 s11, s9, s11
    s_add_u32 s10, s10, 1
    s_lshl_b32 s9, s11, 10
    s_add_u32 s9, s9, s23
    s_add_u32 s12, s24, 16384
    s_lshl_b32 s34, s10, 14
    s_add_u32 s34, s34, s9
    s_lshl_b32 s20, s10, 11
    s_add_u32 s20, s20, s24
    s_add_u32 s20, s20, 65536
    s_cmp_eq_u32 s11, 8
    s_cselect_b32 s9, s12, s9
    s_cselect_b32 s34, s20, s34
    s_add_u32 s34, s34, 12288
    s_add_u32 s10, s10, s5
    s_and_b32 s10, s10, 3
    s_mul_i32 s10, s10, 18432
    s_add_u32 s9, s9, s10
    s_add_u32 s20, s9, s78
    s_add_u32 s9, s8, 20
    s_mul_i32 s10, s9, 7282
    s_lshr_b32 s10, s10, 16
    s_mul_i32 s11, s10, 9
    s_sub_u32 s11, s9, s11
    s_add_u32 s10, s10, 1
    s_lshl_b32 s9, s11, 10
    s_add_u32 s9, s9, s23
    s_add_u32 s12, s24, 16384
    s_lshl_b32 s35, s10, 14
    s_add_u32 s35, s35, s9
    s_lshl_b32 s21, s10, 11
    s_add_u32 s21, s21, s24
    s_add_u32 s21, s21, 65536
    s_cmp_eq_u32 s11, 8
    s_cselect_b32 s9, s12, s9
    s_cselect_b32 s35, s21, s35
    s_add_u32 s35, s35, 12288
    s_add_u32 s10, s10, s5
    s_and_b32 s10, s10, 3
    s_mul_i32 s10, s10, 18432
    s_add_u32 s9, s9, s10
    s_add_u32 s21, s9, s78
    s_add_u32 s9, s8, 24
    s_min_u32 s9, s9, 26
    s_mul_i32 s10, s9, 7282
    s_lshr_b32 s10, s10, 16
    s_mul_i32 s11, s10, 9
    s_sub_u32 s11, s9, s11
    s_add_u32 s10, s10, 1
    s_lshl_b32 s9, s11, 10
    s_add_u32 s9, s9, s23
    s_add_u32 s12, s24, 16384
    s_lshl_b32 s36, s10, 14
    s_add_u32 s36, s36, s9
    s_lshl_b32 s22, s10, 11
    s_add_u32 s22, s22, s24
    s_add_u32 s22, s22, 65536
    s_cmp_eq_u32 s11, 8
    s_cselect_b32 s9, s12, s9
    s_cselect_b32 s36, s22, s36
    s_add_u32 s36, s36, 12288
    s_add_u32 s10, s10, s5
    s_and_b32 s10, s10, 3
    s_mul_i32 s10, s10, 18432
    s_add_u32 s9, s9, s10
    s_add_u32 s22, s9, s78
    s_mul_i32 s9, s7, 147456
    s_mul_i32 s10, s4, 1152
    s_add_u32 s9, s9, s10
    s_mul_i32 s10, s5, 288
    s_add_u32 s9, s9, s10
    s_lshl_b32 s10, s8, 6
    s_add_u32 s10, s10, s9
    s_xor_b32 s11, s8, 0
    s_mul_i32 s11, s11, 36864
    s_add_u32 s37, s11, s10
    s_add_u32 s41, s11, s9
    s_add_u32 s41, s41, 256
    s_xor_b32 s11, s8, 1
    s_mul_i32 s11, s11, 36864
    s_add_u32 s38, s11, s10
    s_xor_b32 s11, s8, 2
    s_mul_i32 s11, s11, 36864
    s_add_u32 s39, s11, s10
    s_xor_b32 s11, s8, 3
    s_mul_i32 s11, s11, 36864
    s_add_u32 s40, s11, s10
    v_mov_b32 v12, 1
    s_mov_b32 s15, 500000
    s_cmp_lg_u32 s3, 7
    s_cbranch_scc1 L_rel2
    s_lshl_b32 s9, s4, 7
L_poll2:
    buffer_load_dword v11, v15, s[68:71], s9 offen offset:4 sc0 sc1
    s_sub_u32 s15, s15, 1
    s_cbranch_scc1 L_poll2d
    s_waitcnt vmcnt(0)
    v_cmp_gt_u32 vcc, 0x80, v11
    s_cbranch_vccz L_poll2d
    s_sleep 16
    s_branch L_poll2
L_poll2d:
    ds_write_b32 v10, v12 offset:4
    s_branch L_rel2d
L_rel2:
    ds_read_b32 v11, v10 offset:4
    s_sub_u32 s15, s15, 1
    s_cbranch_scc1 L_rel2d
    s_waitcnt lgkmcnt(0)
    v_cmp_ne_u32 vcc, 0, v11
    s_cbranch_vccnz L_rel2d
    s_sleep 16
    s_branch L_rel2
L_rel2d:
    s_mul_i32 s9, s5, 9
    s_lshl_b32 s10, s8, 1
    s_add_u32 s9, s9, s10
    s_mul_i32 s9, s9, 18432
    s_add_u32 s9, s9, 163840
    buffer_load_dwordx4 v[112:115], v1, s[60:63], s9 offen offset:0 sc1
    buffer_load_dwordx4 v[116:119], v1, s[60:63], s9 offen offset:1024 sc1
    buffer_load_dwordx4 v[120:123], v1, s[60:63], s9 offen offset:2048 sc1
    buffer_load_dwordx4 v[124:127], v1, s[60:63], s9 offen offset:3072 sc1
    s_add_u32 s9, s9, 4096
    buffer_load_dwordx4 v[128:131], v1, s[60:63], s9 offen offset:0 sc1
    buffer_load_dwordx4 v[132:135], v1, s[60:63], s9 offen offset:1024 sc1
    buffer_load_dwordx4 v[136:139], v1, s[60:63], s9 offen offset:2048 sc1
    buffer_load_dwordx4 v[140:143], v1, s[60:63], s9 offen offset:3072 sc1
    s_add_u32 s9, s9, 4096
    buffer_load_dwordx4 v[144:147], v1, s[60:63], s9 offen offset:0 sc1
    buffer_load_dwordx4 v[148:151], v1, s[60:63], s9 offen offset:1024 sc1
    buffer_load_dwordx4 v[152:155], v1, s[60:63], s9 offen offset:2048 sc1
    buffer_load_dwordx4 v[156:159], v1, s[60:63], s9 offen offset:3072 sc1
    s_add_u32 s9, s9, 4096
    buffer_load_dwordx4 v[160:163], v1, s[60:63], s9 offen offset:0 sc1
    buffer_load_dwordx4 v[164:167], v1, s[60:63], s9 offen offset:1024 sc1
    buffer_load_dwordx4 v[168:171], v1, s[60:63], s9 offen offset:2048 sc1
    buffer_load_dwordx4 v[172:175], v1, s[60:63], s9 offen offset:3072 sc1
    s_add_u32 s9, s9, 4096
    buffer_load_dwordx4 v[176:179], v1, s[60:63], s9 offen offset:0 sc1
    buffer_load_dwordx4 v[180:183], v1, s[60:63], s9 offen offset:1024 sc1
    buffer_load_dwordx4 v[184:187], v1, s[60:63], s9 offen offset:2048 sc1
    buffer_load_dwordx4 v[188:191], v1, s[60:63], s9 offen offset:3072 sc1
    s_add_u32 s9, s9, 4096
    buffer_load_dwordx4 v[192:195], v1, s[60:63], s9 offen offset:0 sc1
    buffer_load_dwordx4 v[196:199], v1, s[60:63], s9 offen offset:1024 sc1
    buffer_load_dwordx4 v[200:203], v1, s[60:63], s9 offen offset:2048 sc1
    buffer_load_dwordx4 v[204:207], v1, s[60:63], s9 offen offset:3072 sc1
    s_add_u32 s9, s9, 4096
    buffer_load_dwordx4 v[208:211], v1, s[60:63], s9 offen offset:0 sc1
    buffer_load_dwordx4 v[212:215], v1, s[60:63], s9 offen offset:1024 sc1
    buffer_load_dwordx4 v[216:219], v1, s[60:63], s9 offen offset:2048 sc1
    buffer_load_dwordx4 v[220:223], v1, s[60:63], s9 offen offset:3072 sc1
    s_add_u32 s9, s9, 4096
    buffer_load_dwordx4 v[224:227], v1, s[60:63], s9 offen offset:0 sc1
    buffer_load_dwordx4 v[228:231], v1, s[60:63], s9 offen offset:1024 sc1
    buffer_load_dwordx4 v[232:235], v1, s[60:63], s9 offen offset:2048 sc1
    buffer_load_dwordx4 v[236:239], v1, s[60:63], s9 offen offset:3072 sc1
    s_add_u32 s9, s9, 4096
    buffer_load_dwordx4 v[240:243], v1, s[60:63], s9 offen offset:0 sc1
    buffer_load_dwordx4 v[244:247], v1, s[60:63], s9 offen offset:1024 sc1
    buffer_load_dwordx4 v[248:251], v1, s[60:63], s9 offen offset:2048 sc1
    buffer_load_dwordx4 v[252:255], v1, s[60:63], s9 offen offset:3072 sc1
    s_add_u32 s9, s9, 4096
    s_lshl_b32 s9, s8, 10
    s_add_u32 s9, s9, 12288
    v_add_u32 v8, s9, v1
    v_xor_b32 v9, 0x400, v8
    v_xor_b32 v10, 0x800, v8
    v_xor_b32 v11, 0xc00, v8
    v_lshrrev_b32 v6, 4, v0
    v_and_b32 v7, 15, v0
    v_mul_u32_u24 v22, 0x900, v7
    v_lshl_add_u32 v23, v6, 3, v22
    v_lshl_add_u32 v22, v6, 4, v22
    v_lshlrev_b32 v6, 11, v6
    v_lshl_add_u32 v6, v7, 2, v6
    s_lshl_b32 s9, s8, 8
    s_add_u32 s9, s9, 77824
    v_add_u32 v52, s9, v6
    v_xor_b32 v53, 0x100, v52
    v_xor_b32 v54, 0x200, v52
    v_xor_b32 v55, 0x300, v52
    v_add_u32 v16, 0x400, v52
    v_add_u32 v17, 0x400, v53
    v_add_u32 v18, 0x400, v54
    v_add_u32 v19, 0x400, v55
    s_waitcnt vmcnt(0) lgkmcnt(0)
    s_barrier
    s_mul_i32 s9, s5, 9
    s_add_u32 s9, s9, 8
    s_mul_i32 s9, s9, 18432
    s_add_u32 s9, s9, 163840
    s_add_u32 s9, s9, s72
    s_add_u32 m0, s72, 86016
    s_add_u32 s10, s9, 0
    buffer_load_dwordx4 v1, s[60:63], s10 offen sc1 lds
    s_add_u32 m0, s72, 90112
    s_add_u32 s10, s9, 4096
    buffer_load_dwordx4 v1, s[60:63], s10 offen sc1 lds
    s_add_u32 m0, s72, 94208
    s_add_u32 s10, s9, 8192
    buffer_load_dwordx4 v1, s[60:63], s10 offen sc1 lds
    s_add_u32 m0, s72, 98304
    s_add_u32 s10, s9, 12288
    buffer_load_dwordx4 v1, s[60:63], s10 offen sc1 lds
    s_and_b32 s11, s8, 2
    s_sub_u32 s11, 16, s11
    s_lshl_b32 s11, s11, 10
    s_add_u32 s10, s9, s11
    s_add_u32 s11, s11, s72
    s_add_u32 m0, s11, 86016
    s_nop 0
    buffer_load_dwordx4 v1, s[60:63], s10 offen sc1 lds
    s_waitcnt vmcnt(0)
    s_lshl_b32 s9, s8, 11
    s_add_u32 s10, s9, s25
    s_add_u32 s9, s9, 12288
    v_add_u32 v56, s9, v1
    v_lshlrev_b32 v57, 2, v0
    s_lshl_b32 s9, s8, 8
    s_add_u32 s11, s9, s28
    s_add_u32 s9, s9, 77824
    v_add_u32 v58, s9, v57
    s_cmp_eq_u32 s26, 1
    s_setprio 2
    s_barrier
    ds_read_b128 v[60:63], v56
    ds_read_b128 v[64:67], v56 offset:1024
    ds_read_b32 v68, v58
    s_cbranch_scc1 L_hs1
    s_waitcnt lgkmcnt(0)
    buffer_store_dwordx4 v[60:63], v1, s[60:63], s10 offen sc0 sc1
    buffer_store_dwordx4 v[64:67], v1, s[60:63], s10 offen offset:1024 sc0 sc1
    buffer_store_dword v68, v57, s[60:63], s11 offen sc0 sc1
    s_branch L_hs2
L_hs1:
    s_waitcnt lgkmcnt(0)
    buffer_store_dwordx4 v[60:63], v1, s[60:63], s10 offen
    buffer_store_dwordx4 v[64:67], v1, s[60:63], s10 offen offset:1024
    buffer_store_dword v68, v57, s[60:63], s11 offen
L_hs2:
    buffer_load_dwordx4 v[24:27], v1, s[60:63], s16 offen sc0 sc1
    buffer_load_dwordx4 v[28:31], v1, s[60:63], s17 offen sc0 sc1
    buffer_load_dwordx4 v[32:35], v1, s[60:63], s18 offen sc0 sc1
    buffer_load_dwordx4 v[36:39], v1, s[60:63], s19 offen sc0 sc1
    buffer_load_dwordx4 v[40:43], v1, s[60:63], s20 offen sc0 sc1
    buffer_load_dwordx4 v[44:47], v1, s[60:63], s21 offen sc0 sc1
    buffer_load_dwordx4 v[48:51], v1, s[60:63], s22 offen sc0 sc1
    v_add_u32 v2, s30, v1
    v_add_u32 v3, s31, v1
    v_add_u32 v4, s32, v1
    v_add_u32 v5, s33, v1
    v_add_u32 v12, s34, v1
    v_add_u32 v13, s35, v1
    v_add_u32 v14, s36, v1
    s_mov_b32 s15, 500000
L_cll:
    s_waitcnt vmcnt(0)
    v_max3_u32 v6, v24, v25, v26
    v_max3_u32 v7, v27, v28, v29
    v_max3_u32 v6, v6, v30, v31
    v_max3_u32 v7, v7, v32, v33
    v_max3_u32 v6, v6, v34, v35
    v_max3_u32 v7, v7, v36, v37
    v_max3_u32 v6, v6, v38, v39
    v_max3_u32 v7, v7, v40, v41
    v_max3_u32 v6, v6, v42, v43
    v_max3_u32 v7, v7, v44, v45
    v_max3_u32 v6, v6, v46, v47
    v_max3_u32 v7, v7, v48, v49
    v_max3_u32 v6, v6, v50, v51
    v_max_u32 v7, v7, v6
    v_cmp_eq_u32 vcc, -1, v7
    s_cbranch_vccz L_cldl
    s_sub_u32 s15, s15, 1
    s_cbranch_scc1 L_cldl
    buffer_load_dwordx4 v[24:27], v1, s[60:63], s16 offen sc0 sc1
    buffer_load_dwordx4 v[28:31], v1, s[60:63], s17 offen sc0 sc1
    buffer_load_dwordx4 v[32:35], v1, s[60:63], s18 offen sc0 sc1
    buffer_load_dwordx4 v[36:39], v1, s[60:63], s19 offen sc0 sc1
    buffer_load_dwordx4 v[40:43], v1, s[60:63], s20 offen sc0 sc1
    buffer_load_dwordx4 v[44:47], v1, s[60:63], s21 offen sc0 sc1
    buffer_load_dwordx4 v[48:51], v1, s[60:63], s22 offen sc0 sc1
    s_branch L_cll
L_cldl:
    ds_write_b128 v2, v[24:27]
    ds_write_b128 v3, v[28:31]
    ds_write_b128 v4, v[32:35]
    ds_write_b128 v5, v[36:39]
    ds_write_b128 v12, v[40:43]
    ds_write_b128 v13, v[44:47]
    ds_write_b128 v14, v[48:51]
    s_waitcnt lgkmcnt(0)
    s_barrier
    s_setprio 1
    v_add_u32 v21, 86016, v1
    v_mov_b32 v20, 10260
    ds_read_b128 v[56:59], v8 offset:0
    ds_read_b128 v[24:27], v21 offset:0
    ds_read_b128 v[60:63], v9 offset:0
    ds_read_b128 v[64:67], v10 offset:0
    ds_read_b128 v[68:71], v11 offset:0
    ds_read_b128 v[72:75], v8 offset:4096
    ds_read_b128 v[40:43], v21 offset:1024
    s_waitcnt lgkmcnt(5)
    v_mfma_f32_16x16x32_bf16 v[80:83], v[112:115], v[56:59], 0
    ds_read_b128 v[76:79], v9 offset:4096
    v_mfma_f32_16x16x32_bf16 v[96:99], v[184:187], v[56:59], 0
    v_mfma_f32_16x16x32_bf16 v[48:51], v[24:27], v[56:59], 0
    s_waitcnt lgkmcnt(5)
    v_mfma_f32_16x16x32_bf16 v[84:87], v[112:115], v[60:63], 0
    ds_read_b128 v[56:59], v10 offset:4096
    v_mfma_f32_16x16x32_bf16 v[100:103], v[184:187], v[60:63], 0
    s_waitcnt lgkmcnt(5)
    v_mfma_f32_16x16x32_bf16 v[88:91], v[112:115], v[64:67], 0
    ds_read_b128 v[60:63], v11 offset:4096
    v_mfma_f32_16x16x32_bf16 v[104:107], v[184:187], v[64:67], 0
    s_waitcnt lgkmcnt(5)
    v_mfma_f32_16x16x32_bf16 v[92:95], v[112:115], v[68:71], 0
    ds_read_b128 v[64:67], v8 offset:16384
    v_mfma_f32_16x16x32_bf16 v[108:111], v[184:187], v[68:71], 0
    ds_read_b128 v[32:35], v21 offset:4096
    s_waitcnt lgkmcnt(5)
    v_mfma_f32_16x16x32_bf16 v[80:83], v[116:119], v[72:75], v[80:83]
    ds_read_b128 v[68:71], v9 offset:16384
    v_mfma_f32_16x16x32_bf16 v[96:99], v[188:191], v[72:75], v[96:99]
    v_mfma_f32_16x16x32_bf16 v[48:51], v[40:43], v[72:75], v[48:51]
    s_waitcnt lgkmcnt(5)
    v_mfma_f32_16x16x32_bf16 v[84:87], v[116:119], v[76:79], v[84:87]
    ds_read_b128 v[72:75], v10 offset:16384
    v_mfma_f32_16x16x32_bf16 v[100:103], v[188:191], v[76:79], v[100:103]
    s_waitcnt lgkmcnt(5)
    v_mfma_f32_16x16x32_bf16 v[88:91], v[116:119], v[56:59], v[88:91]
    ds_read_b128 v[76:79], v11 offset:16384
    v_mfma_f32_16x16x32_bf16 v[104:107], v[188:191], v[56:59], v[104:107]
    s_waitcnt lgkmcnt(5)
    v_mfma_f32_16x16x32_bf16 v[92:95], v[116:119], v[60:63], v[92:95]
    ds_read_b128 v[56:59], v8 offset:20480
    v_mfma_f32_16x16x32_bf16 v[108:111], v[188:191], v[60:63], v[108:111]
    ds_read_b128 v[24:27], v21 offset:5120
    s_waitcnt lgkmcnt(5)
    v_mfma_f32_16x16x32_bf16 v[80:83], v[128:131], v[64:67], v[80:83]
    ds_read_b128 v[60:63], v9 offset:20480
    v_mfma_f32_16x16x32_bf16 v[96:99], v[200:203], v[64:67], v[96:99]
    v_mfma_f32_16x16x32_bf16 v[48:51], v[32:35], v[64:67], v[48:51]
    s_waitcnt lgkmcnt(5)
    v_mfma_f32_16x16x32_bf16 v[84:87], v[128:131], v[68:71], v[84:87]
    ds_read_b128 v[64:67], v10 offset:20480
    v_mfma_f32_16x16x32_bf16 v[100:103], v[200:203], v[68:71], v[100:103]
    s_waitcnt lgkmcnt(5)
    v_mfma_f32_16x16x32_bf16 v[88:91], v[128:131], v[72:75], v[88:91]
    ds_read_b128 v[68:71], v11 offset:20480
    v_mfma_f32_16x16x32_bf16 v[104:107], v[200:203], v[72:75], v[104:107]
    s_waitcnt lgkmcnt(5)
    v_mfma_f32_16x16x32_bf16 v[92:95], v[128:131], v[76:79], v[92:95]
    ds_read_b128 v[72:75], v8 offset:32768
    v_mfma_f32_16x16x32_bf16 v[108:111], v[200:203], v[76:79], v[108:111]
    ds_read_b128 v[40:43], v21 offset:8192
    s_waitcnt lgkmcnt(5)
    v_mfma_f32_16x16x32_bf16 v[80:83], v[132:135], v[56:59], v[80:83]
    ds_read_b128 v[76:79], v9 offset:32768
    v_mfma_f32_16x16x32_bf16 v[96:99], v[204:207], v[56:59], v[96:99]
    v_mfma_f32_16x16x32_bf16 v[48:51], v[24:27], v[56:59], v[48:51]
    s_waitcnt lgkmcnt(5)
    v_mfma_f32_16x16x32_bf16 v[84:87], v[132:135], v[60:63], v[84:87]
    ds_read_b128 v[56:59], v10 offset:32768
    v_mfma_f32_16x16x32_bf16 v[100:103], v[204:207], v[60:63], v[100:103]
    s_waitcnt lgkmcnt(5)
    v_mfma_f32_16x16x32_bf16 v[88:91], v[132:135], v[64:67], v[88:91]
    ds_read_b128 v[60:63], v11 offset:32768
    v_mfma_f32_16x16x32_bf16 v[104:107], v[204:207], v[64:67], v[104:107]
    s_waitcnt lgkmcnt(5)
    v_mfma_f32_16x16x32_bf16 v[92:95], v[132:135], v[68:71], v[92:95]
    ds_read_b128 v[64:67], v8 offset:36864
    v_mfma_f32_16x16x32_bf16 v[108:111], v[204:207], v[68:71], v[108:111]
    ds_read_b128 v[32:35], v21 offset:9216
    s_waitcnt lgkmcnt(5)
    v_mfma_f32_16x16x32_bf16 v[80:83], v[144:147], v[72:75], v[80:83]
    ds_read_b128 v[68:71], v9 offset:36864
    v_mfma_f32_16x16x32_bf16 v[96:99], v[216:219], v[72:75], v[96:99]
    v_mfma_f32_16x16x32_bf16 v[48:51], v[40:43], v[72:75], v[48:51]
    s_waitcnt lgkmcnt(5)
    v_mfma_f32_16x16x32_bf16 v[84:87], v[144:147], v[76:79], v[84:87]
    ds_read_b128 v[72:75], v10 offset:36864
    v_mfma_f32_16x16x32_bf16 v[100:103], v[216:219], v[76:79], v[100:103]
    s_waitcnt lgkmcnt(5)
    v_mfma_f32_16x16x32_bf16 v[88:91], v[144:147], v[56:59], v[88:91]
    ds_read_b128 v[76:79], v11 offset:36864
    v_mfma_f32_16x16x32_bf16 v[104:107], v[216:219], v[56:59], v[104:107]
    s_waitcnt lgkmcnt(5)
    v_mfma_f32_16x16x32_bf16 v[92:95], v[144:147], v[60:63], v[92:95]
    ds_read_b128 v[56:59], v8 offset:49152
    v_mfma_f32_16x16x32_bf16 v[108:111], v[216:219], v[60:63], v[108:111]
    ds_read_b128 v[24:27], v21 offset:12288
    s_waitcnt lgkmcnt(5)
    v_mfma_f32_16x16x32_bf16 v[80:83], v[148:151], v[64:67], v[80:83]
    ds_read_b128 v[60:63], v9 offset:49152
    v_mfma_f32_16x16x32_bf16 v[96:99], v[220:223], v[64:67], v[96:99]
    v_mfma_f32_16x16x32_bf16 v[48:51], v[32:35], v[64:67], v[48:51]
    s_waitcnt lgkmcnt(5)
    v_mfma_f32_16x16x32_bf16 v[84:87], v[148:151], v[68:71], v[84:87]
    ds_read_b128 v[64:67], v10 offset:49152
    v_mfma_f32_16x16x32_bf16 v[100:103], v[220:223], v[68:71], v[100:103]
    s_waitcnt lgkmcnt(5)
    v_mfma_f32_16x16x32_bf16 v[88:91], v[148:151], v[72:75], v[88:91]
    ds_read_b128 v[68:71], v11 offset:49152
    v_mfma_f32_16x16x32_bf16 v[104:107], v[220:223], v[72:75], v[104:107]
    s_waitcnt lgkmcnt(5)
    v_mfma_f32_16x16x32_bf16 v[92:95], v[148:151], v[76:79], v[92:95]
    ds_read_b128 v[72:75], v8 offset:53248
    v_mfma_f32_16x16x32_bf16 v[108:111], v[220:223], v[76:79], v[108:111]
    ds_read_b128 v[40:43], v21 offset:13312
    s_waitcnt lgkmcnt(5)
    v_mfma_f32_16x16x32_bf16 v[80:83], v[160:163], v[56:59], v[80:83]
    ds_read_b128 v[76:79], v9 offset:53248
    v_mfma_f32_16x16x32_bf16 v[96:99], v[232:235], v[56:59], v[96:99]
    v_mfma_f32_16x16x32_bf16 v[48:51], v[24:27], v[56:59], v[48:51]
    s_waitcnt lgkmcnt(5)
    v_mfma_f32_16x16x32_bf16 v[84:87], v[160:163], v[60:63], v[84:87]
    ds_read_b128 v[56:59], v10 offset:53248
    v_mfma_f32_16x16x32_bf16 v[100:103], v[232:235], v[60:63], v[100:103]
    s_waitcnt lgkmcnt(5)
    v_mfma_f32_16x16x32_bf16 v[88:91], v[160:163], v[64:67], v[88:91]
    ds_read_b128 v[60:63], v11 offset:53248
    v_mfma_f32_16x16x32_bf16 v[104:107], v[232:235], v[64:67], v[104:107]
    s_waitcnt lgkmcnt(5)
    v_mfma_f32_16x16x32_bf16 v[92:95], v[160:163], v[68:71], v[92:95]
    ds_read2_b32 v[64:65], v52 offset0:0 offset1:16
    v_mfma_f32_16x16x32_bf16 v[108:111], v[232:235], v[68:71], v[108:111]
    ds_read2_b32 v[66:67], v52 offset0:32 offset1:48
    ds_read_b128 v[32:35], v21 offset:16384
    s_waitcnt lgkmcnt(6)
    v_mfma_f32_16x16x32_bf16 v[80:83], v[164:167], v[72:75], v[80:83]
    ds_read2_b32 v[68:69], v53 offset0:0 offset1:16
    v_mfma_f32_16x16x32_bf16 v[96:99], v[236:239], v[72:75], v[96:99]
    ds_read2_b32 v[70:71], v53 offset0:32 offset1:48
    v_mfma_f32_16x16x32_bf16 v[48:51], v[40:43], v[72:75], v[48:51]
    s_waitcnt lgkmcnt(7)
    v_mfma_f32_16x16x32_bf16 v[84:87], v[164:167], v[76:79], v[84:87]
    ds_read2_b32 v[72:73], v54 offset0:0 offset1:16
    v_mfma_f32_16x16x32_bf16 v[100:103], v[236:239], v[76:79], v[100:103]
    ds_read2_b32 v[74:75], v54 offset0:32 offset1:48
    s_waitcnt lgkmcnt(8)
    v_mfma_f32_16x16x32_bf16 v[88:91], v[164:167], v[56:59], v[88:91]
    ds_read2_b32 v[76:77], v55 offset0:0 offset1:16
    v_mfma_f32_16x16x32_bf16 v[104:107], v[236:239], v[56:59], v[104:107]
    ds_read2_b32 v[78:79], v55 offset0:32 offset1:48
    s_waitcnt lgkmcnt(9)
    v_mfma_f32_16x16x32_bf16 v[92:95], v[164:167], v[60:63], v[92:95]
    v_mfma_f32_16x16x32_bf16 v[108:111], v[236:239], v[60:63], v[108:111]
    s_waitcnt lgkmcnt(6)
    v_mfma_f32_16x16x32_bf16 v[80:83], v[176:179], v[64:67], v[80:83]
    v_mfma_f32_16x16x32_bf16 v[96:99], v[248:251], v[64:67], v[96:99]
    v_mfma_f32_16x16x32_bf16 v[48:51], v[32:35], v[64:67], v[48:51]
    s_waitcnt lgkmcnt(4)
    v_mfma_f32_16x16x32_bf16 v[84:87], v[176:179], v[68:71], v[84:87]
    v_mfma_f32_16x16x32_bf16 v[100:103], v[248:251], v[68:71], v[100:103]
    s_waitcnt lgkmcnt(2)
    v_mfma_f32_16x16x32_bf16 v[88:91], v[176:179], v[72:75], v[88:91]
    v_mfma_f32_16x16x32_bf16 v[104:107], v[248:251], v[72:75], v[104:107]
    s_waitcnt lgkmcnt(0)
    v_mfma_f32_16x16x32_bf16 v[92:95], v[176:179], v[76:79], v[92:95]
    v_mfma_f32_16x16x32_bf16 v[108:111], v[248:251], v[76:79], v[108:111]
    s_setprio 3
    s_barrier
    ds_read_b128 v[64:67], v8 offset:8192
    ds_read_b128 v[32:35], v21 offset:2048
    ds_read_b128 v[68:71], v8 offset:12288
    ds_read_b128 v[36:39], v21 offset:3072
    ds_read_b128 v[72:75], v8 offset:24576
    ds_read_b128 v[40:43], v21 offset:6144
    ds_read_b128 v[76:79], v8 offset:28672
    ds_read_b128 v[44:47], v21 offset:7168
    ds_read_b128 v[56:59], v8 offset:40960
    ds_read_b128 v[24:27], v21 offset:10240
    s_waitcnt lgkmcnt(8)
    v_mfma_f32_16x16x32_bf16 v[80:83], v[120:123], v[64:67], v[80:83]
    ds_read_b128 v[60:63], v8 offset:45056
    v_mfma_f32_16x16x32_bf16 v[96:99], v[192:195], v[64:67], v[96:99]
    ds_read_b128 v[28:31], v21 offset:11264
    v_mfma_f32_16x16x32_bf16 v[48:51], v[32:35], v[64:67], v[48:51]
    s_waitcnt lgkmcnt(8)
    v_mfma_f32_16x16x32_bf16 v[80:83], v[124:127], v[68:71], v[80:83]
    ds_read_b128 v[64:67], v8 offset:57344
    v_mfma_f32_16x16x32_bf16 v[96:99], v[196:199], v[68:71], v[96:99]
    ds_read_b128 v[32:35], v21 offset:14336
    v_mfma_f32_16x16x32_bf16 v[48:51], v[36:39], v[68:71], v[48:51]
    s_waitcnt lgkmcnt(8)
    v_mfma_f32_16x16x32_bf16 v[80:83], v[136:139], v[72:75], v[80:83]
    ds_read_b128 v[68:71], v8 offset:61440
    v_mfma_f32_16x16x32_bf16 v[96:99], v[208:211], v[72:75], v[96:99]
    ds_read_b128 v[36:39], v21 offset:15360
    v_mfma_f32_16x16x32_bf16 v[48:51], v[40:43], v[72:75], v[48:51]
    s_waitcnt lgkmcnt(8)
    v_mfma_f32_16x16x32_bf16 v[80:83], v[140:143], v[76:79], v[80:83]
    ds_read2_b32 v[72:73], v16 offset0:0 offset1:16
    v_mfma_f32_16x16x32_bf16 v[96:99], v[212:215], v[76:79], v[96:99]
    ds_read2_b32 v[74:75], v16 offset0:32 offset1:48
    v_mfma_f32_16x16x32_bf16 v[48:51], v[44:47], v[76:79], v[48:51]
    ds_read_b128 v[40:43], v21 offset:17408
    s_waitcnt lgkmcnt(9)
    v_mfma_f32_16x16x32_bf16 v[80:83], v[152:155], v[56:59], v[80:83]
    ds_read_b128 v[76:79], v9 offset:8192
    v_mfma_f32_16x16x32_bf16 v[96:99], v[224:227], v[56:59], v[96:99]
    v_mfma_f32_16x16x32_bf16 v[48:51], v[24:27], v[56:59], v[48:51]
    s_waitcnt lgkmcnt(8)
    v_mfma_f32_16x16x32_bf16 v[80:83], v[156:159], v[60:63], v[80:83]
    ds_read_b128 v[56:59], v9 offset:12288
    v_mfma_f32_16x16x32_bf16 v[96:99], v[228:231], v[60:63], v[96:99]
    v_mfma_f32_16x16x32_bf16 v[48:51], v[28:31], v[60:63], v[48:51]
    s_waitcnt lgkmcnt(7)
    v_mfma_f32_16x16x32_bf16 v[80:83], v[168:171], v[64:67], v[80:83]
    ds_read_b128 v[60:63], v9 offset:24576
    v_mfma_f32_16x16x32_bf16 v[96:99], v[240:243], v[64:67], v[96:99]
    v_mfma_f32_16x16x32_bf16 v[48:51], v[32:35], v[64:67], v[48:51]
    s_waitcnt lgkmcnt(6)
    v_mfma_f32_16x16x32_bf16 v[80:83], v[172:175], v[68:71], v[80:83]
    ds_read_b128 v[64:67], v9 offset:28672
    v_mfma_f32_16x16x32_bf16 v[96:99], v[244:247], v[68:71], v[96:99]
    v_mfma_f32_16x16x32_bf16 v[48:51], v[36:39], v[68:71], v[48:51]
    s_waitcnt lgkmcnt(4)
    v_mfma_f32_16x16x32_bf16 v[80:83], v[180:183], v[72:75], v[80:83]
    ds_read_b128 v[68:71], v9 offset:40960
    v_mfma_f32_16x16x32_bf16 v[96:99], v[252:255], v[72:75], v[96:99]
    v_mfma_f32_16x16x32_bf16 v[48:51], v[40:43], v[72:75], v[48:51]
    s_waitcnt lgkmcnt(4)
    v_mfma_f32_16x16x32_bf16 v[84:87], v[120:123], v[76:79], v[84:87]
    ds_read_b128 v[72:75], v9 offset:45056
    v_mfma_f32_16x16x32_bf16 v[100:103], v[192:195], v[76:79], v[100:103]
    s_waitcnt lgkmcnt(4)
    v_mfma_f32_16x16x32_bf16 v[84:87], v[124:127], v[56:59], v[84:87]
    ds_read_b128 v[76:79], v9 offset:57344
    v_mfma_f32_16x16x32_bf16 v[100:103], v[196:199], v[56:59], v[100:103]
    s_waitcnt lgkmcnt(4)
    v_mfma_f32_16x16x32_bf16 v[84:87], v[136:139], v[60:63], v[84:87]
    ds_read_b128 v[56:59], v9 offset:61440
    v_mfma_f32_16x16x32_bf16 v[100:103], v[208:211], v[60:63], v[100:103]
    v_cvt_pk_bf16_f32 v4, v80, v81
    v_cvt_pk_bf16_f32 v5, v82, v83
    v_cvt_pk_bf16_f32 v6, v96, v97
    v_cvt_pk_bf16_f32 v7, v98, v99
    buffer_store_dwordx4 v[4:7], v22, s[64:67], s37 offen
    v_cvt_pk_bf16_f32 v2, v48, v49
    v_cvt_pk_bf16_f32 v3, v50, v51
    buffer_store_dwordx2 v[2:3], v23, s[64:67], s41 offen
    s_waitcnt lgkmcnt(4)
    v_mfma_f32_16x16x32_bf16 v[84:87], v[140:143], v[64:67], v[84:87]
    ds_read2_b32 v[60:61], v17 offset0:0 offset1:16
    v_mfma_f32_16x16x32_bf16 v[100:103], v[212:215], v[64:67], v[100:103]
    ds_read2_b32 v[62:63], v17 offset0:32 offset1:48
    s_waitcnt lgkmcnt(5)
    v_mfma_f32_16x16x32_bf16 v[84:87], v[152:155], v[68:71], v[84:87]
    ds_read_b128 v[64:67], v10 offset:8192
    v_mfma_f32_16x16x32_bf16 v[100:103], v[224:227], v[68:71], v[100:103]
    s_waitcnt lgkmcnt(5)
    v_mfma_f32_16x16x32_bf16 v[84:87], v[156:159], v[72:75], v[84:87]
    ds_read_b128 v[68:71], v10 offset:12288
    v_mfma_f32_16x16x32_bf16 v[100:103], v[228:231], v[72:75], v[100:103]
    s_waitcnt lgkmcnt(5)
    v_mfma_f32_16x16x32_bf16 v[84:87], v[168:171], v[76:79], v[84:87]
    ds_read_b128 v[72:75], v10 offset:24576
    v_mfma_f32_16x16x32_bf16 v[100:103], v[240:243], v[76:79], v[100:103]
    s_waitcnt lgkmcnt(5)
    v_mfma_f32_16x16x32_bf16 v[84:87], v[172:175], v[56:59], v[84:87]
    ds_read_b128 v[76:79], v10 offset:28672
    v_mfma_f32_16x16x32_bf16 v[100:103], v[244:247], v[56:59], v[100:103]
    s_waitcnt lgkmcnt(4)
    v_mfma_f32_16x16x32_bf16 v[84:87], v[180:183], v[60:63], v[84:87]
    ds_read_b128 v[56:59], v10 offset:40960
    v_mfma_f32_16x16x32_bf16 v[100:103], v[252:255], v[60:63], v[100:103]
    s_waitcnt lgkmcnt(4)
    v_mfma_f32_16x16x32_bf16 v[88:91], v[120:123], v[64:67], v[88:91]
    ds_read_b128 v[60:63], v10 offset:45056
    v_mfma_f32_16x16x32_bf16 v[104:107], v[192:195], v[64:67], v[104:107]
    s_waitcnt lgkmcnt(4)
    v_mfma_f32_16x16x32_bf16 v[88:91], v[124:127], v[68:71], v[88:91]
    ds_read_b128 v[64:67], v10 offset:57344
    v_mfma_f32_16x16x32_bf16 v[104:107], v[196:199], v[68:71], v[104:107]
    s_waitcnt lgkmcnt(4)
    v_mfma_f32_16x16x32_bf16 v[88:91], v[136:139], v[72:75], v[88:91]
    ds_read_b128 v[68:71], v10 offset:61440
    v_mfma_f32_16x16x32_bf16 v[104:107], v[208:211], v[72:75], v[104:107]
    v_cvt_pk_bf16_f32 v12, v84, v85
    v_cvt_pk_bf16_f32 v13, v86, v87
    v_cvt_pk_bf16_f32 v14, v100, v101
    v_cvt_pk_bf16_f32 v15, v102, v103
    buffer_store_dwordx4 v[12:15], v22, s[64:67], s38 offen
    s_waitcnt lgkmcnt(4)
    v_mfma_f32_16x16x32_bf16 v[88:91], v[140:143], v[76:79], v[88:91]
    ds_read2_b32 v[72:73], v18 offset0:0 offset1:16
    v_mfma_f32_16x16x32_bf16 v[104:107], v[212:215], v[76:79], v[104:107]
    ds_read2_b32 v[74:75], v18 offset0:32 offset1:48
    s_waitcnt lgkmcnt(5)
    v_mfma_f32_16x16x32_bf16 v[88:91], v[152:155], v[56:59], v[88:91]
    ds_read_b128 v[76:79], v11 offset:8192
    v_mfma_f32_16x16x32_bf16 v[104:107], v[224:227], v[56:59], v[104:107]
    s_waitcnt lgkmcnt(5)
    v_mfma_f32_16x16x32_bf16 v[88:91], v[156:159], v[60:63], v[88:91]
    ds_read_b128 v[56:59], v11 offset:12288
    v_mfma_f32_16x16x32_bf16 v[104:107], v[228:231], v[60:63], v[104:107]
    s_waitcnt lgkmcnt(5)
    v_mfma_f32_16x16x32_bf16 v[88:91], v[168:171], v[64:67], v[88:91]
    ds_read_b128 v[60:63], v11 offset:24576
    v_mfma_f32_16x16x32_bf16 v[104:107], v[240:243], v[64:67], v[104:107]
    s_waitcnt lgkmcnt(5)
    v_mfma_f32_16x16x32_bf16 v[88:91], v[172:175], v[68:71], v[88:91]
    ds_read_b128 v[64:67], v11 offset:28672
    v_mfma_f32_16x16x32_bf16 v[104:107], v[244:247], v[68:71], v[104:107]
    s_waitcnt lgkmcnt(4)
    v_mfma_f32_16x16x32_bf16 v[88:91], v[180:183], v[72:75], v[88:91]
    ds_read_b128 v[68:71], v11 offset:40960
    v_mfma_f32_16x16x32_bf16 v[104:107], v[252:255], v[72:75], v[104:107]
    s_waitcnt lgkmcnt(4)
    v_mfma_f32_16x16x32_bf16 v[92:95], v[120:123], v[76:79], v[92:95]
    ds_read_b128 v[72:75], v11 offset:45056
    v_mfma_f32_16x16x32_bf16 v[108:111], v[192:195], v[76:79], v[108:111]
    s_waitcnt lgkmcnt(4)
    v_mfma_f32_16x16x32_bf16 v[92:95], v[124:127], v[56:59], v[92:95]
    ds_read_b128 v[76:79], v11 offset:57344
    v_mfma_f32_16x16x32_bf16 v[108:111], v[196:199], v[56:59], v[108:111]
    s_waitcnt lgkmcnt(4)
    v_mfma_f32_16x16x32_bf16 v[92:95], v[136:139], v[60:63], v[92:95]
    ds_read_b128 v[56:59], v11 offset:61440
    v_mfma_f32_16x16x32_bf16 v[108:111], v[208:211], v[60:63], v[108:111]
    v_cvt_pk_bf16_f32 v4, v88, v89
    v_cvt_pk_bf16_f32 v5, v90, v91
    v_cvt_pk_bf16_f32 v6, v104, v105
    v_cvt_pk_bf16_f32 v7, v106, v107
    buffer_store_dwordx4 v[4:7], v22, s[64:67], s39 offen
    s_waitcnt lgkmcnt(4)
    v_mfma_f32_16x16x32_bf16 v[92:95], v[140:143], v[64:67], v[92:95]
    ds_read2_b32 v[60:61], v19 offset0:0 offset1:16
    v_mfma_f32_16x16x32_bf16 v[108:111], v[212:215], v[64:67], v[108:111]
    ds_read2_b32 v[62:63], v19 offset0:32 offset1:48
    s_waitcnt lgkmcnt(5)
    v_mfma_f32_16x16x32_bf16 v[92:95], v[152:155], v[68:71], v[92:95]
    v_mfma_f32_16x16x32_bf16 v[108:111], v[224:227], v[68:71], v[108:111]
    s_waitcnt lgkmcnt(4)
    v_mfma_f32_16x16x32_bf16 v[92:95], v[156:159], v[72:75], v[92:95]
    v_mfma_f32_16x16x32_bf16 v[108:111], v[228:231], v[72:75], v[108:111]
    s_waitcnt lgkmcnt(3)
    v_mfma_f32_16x16x32_bf16 v[92:95], v[168:171], v[76:79], v[92:95]
    v_mfma_f32_16x16x32_bf16 v[108:111], v[240:243], v[76:79], v[108:111]
    s_waitcnt lgkmcnt(2)
    v_mfma_f32_16x16x32_bf16 v[92:95], v[172:175], v[56:59], v[92:95]
    v_mfma_f32_16x16x32_bf16 v[108:111], v[244:247], v[56:59], v[108:111]
    s_waitcnt lgkmcnt(0)
    v_mfma_f32_16x16x32_bf16 v[92:95], v[180:183], v[60:63], v[92:95]
    v_mfma_f32_16x16x32_bf16 v[108:111], v[252:255], v[60:63], v[108:111]
    s_nop 6
    v_cvt_pk_bf16_f32 v12, v92, v93
    v_cvt_pk_bf16_f32 v13, v94, v95
    v_cvt_pk_bf16_f32 v14, v108, v109
    v_cvt_pk_bf16_f32 v15, v110, v111
    buffer_store_dwordx4 v[12:15], v22, s[64:67], s40 offen
    s_branch L_fin
L_fallback:
    s_barrier
    s_mov_b32 s75, 1
    v_mov_b32 v17, 0
    v_mov_b32 v157, 0
    v_mov_b32 v192, v3
    v_mov_b32 v193, v4
    v_mov_b32 v194, 0xff800000
    v_mov_b32 v195, 0xff800000
    v_mov_b32 v196, 0xff800000
    v_mov_b32 v197, 0xff800000
    v_mov_b32 v199, 0x3f803f80
    s_mov_b32 s15, 32
L_fbl:
    ds_read_b32 v198, v193
    ds_read_b128 v[200:203], v192
    ds_read_b128 v[204:207], v192 offset:1024
    v_add_u32 v192, 4736, v192
    v_add_u32 v193, 4736, v193
    s_waitcnt lgkmcnt(0)
    v_mfma_f32_32x32x4_2b_bf16 v[208:239], v[198:199], v[16:17], 0 cbsz:1 abid:0
    s_nop 15
    s_nop 1
    v_mfma_f32_32x32x16_bf16 v[208:223], v[200:203], v[8:11], v[208:223]
    v_mfma_f32_32x32x16_bf16 v[224:239], v[200:203], v[12:15], v[224:239]
    s_nop 11
    v_max3_f32 v194, v194, v208, v209
    v_max3_f32 v195, v195, v224, v225
    v_max3_f32 v194, v194, v210, v211
    v_max3_f32 v195, v195, v226, v227
    v_max3_f32 v194, v194, v212, v213
    v_max3_f32 v195, v195, v228, v229
    v_max3_f32 v194, v194, v214, v215
    v_max3_f32 v195, v195, v230, v231
    v_max3_f32 v194, v194, v216, v217
    v_max3_f32 v195, v195, v232, v233
    v_max3_f32 v194, v194, v218, v219
    v_max3_f32 v195, v195, v234, v235
    v_max3_f32 v194, v194, v220, v221
    v_max3_f32 v195, v195, v236, v237
    v_max3_f32 v194, v194, v222, v223
    v_max3_f32 v195, v195, v238, v239
    v_mfma_f32_32x32x4_2b_bf16 v[208:239], v[198:199], v[156:157], 0 cbsz:1 abid:0
    s_nop 15
    s_nop 1
    v_mfma_f32_32x32x16_bf16 v[208:223], v[200:203], v[148:151], v[208:223]
    v_mfma_f32_32x32x16_bf16 v[224:239], v[200:203], v[152:155], v[224:239]
    s_nop 11
    v_max3_f32 v196, v196, v208, v209
    v_max3_f32 v197, v197, v224, v225
    v_max3_f32 v196, v196, v210, v211
    v_max3_f32 v197, v197, v226, v227
    v_max3_f32 v196, v196, v212, v213
    v_max3_f32 v197, v197, v228, v229
    v_max3_f32 v196, v196, v214, v215
    v_max3_f32 v197, v197, v230, v231
    v_max3_f32 v196, v196, v216, v217
    v_max3_f32 v197, v197, v232, v233
    v_max3_f32 v196, v196, v218, v219
    v_max3_f32 v197, v197, v234, v235
    v_max3_f32 v196, v196, v220, v221
    v_max3_f32 v197, v197, v236, v237
    v_max3_f32 v196, v196, v222, v223
    v_max3_f32 v197, v197, v238, v239
    v_mfma_f32_32x32x4_2b_bf16 v[208:239], v[198:199], v[16:17], 0 cbsz:1 abid:1
    s_nop 15
    s_nop 1
    v_mfma_f32_32x32x16_bf16 v[208:223], v[204:207], v[8:11], v[208:223]
    v_mfma_f32_32x32x16_bf16 v[224:239], v[204:207], v[12:15], v[224:239]
    s_nop 11
    v_max3_f32 v194, v194, v208, v209
    v_max3_f32 v195, v195, v224, v225
    v_max3_f32 v194, v194, v210, v211
    v_max3_f32 v195, v195, v226, v227
    v_max3_f32 v194, v194, v212, v213
    v_max3_f32 v195, v195, v228, v229
    v_max3_f32 v194, v194, v214, v215
    v_max3_f32 v195, v195, v230, v231
    v_max3_f32 v194, v194, v216, v217
    v_max3_f32 v195, v195, v232, v233
    v_max3_f32 v194, v194, v218, v219
    v_max3_f32 v195, v195, v234, v235
    v_max3_f32 v194, v194, v220, v221
    v_max3_f32 v195, v195, v236, v237
    v_max3_f32 v194, v194, v222, v223
    v_max3_f32 v195, v195, v238, v239
    v_mfma_f32_32x32x4_2b_bf16 v[208:239], v[198:199], v[156:157], 0 cbsz:1 abid:1
    s_nop 15
    s_nop 1
    v_mfma_f32_32x32x16_bf16 v[208:223], v[204:207], v[148:151], v[208:223]
    v_mfma_f32_32x32x16_bf16 v[224:239], v[204:207], v[152:155], v[224:239]
    s_nop 11
    v_max3_f32 v196, v196, v208, v209
    v_max3_f32 v197, v197, v224, v225
    v_max3_f32 v196, v196, v210, v211
    v_max3_f32 v197, v197, v226, v227
    v_max3_f32 v196, v196, v212, v213
    v_max3_f32 v197, v197, v228, v229
    v_max3_f32 v196, v196, v214, v215
    v_max3_f32 v197, v197, v230, v231
    v_max3_f32 v196, v196, v216, v217
    v_max3_f32 v197, v197, v232, v233
    v_max3_f32 v196, v196, v218, v219
    v_max3_f32 v197, v197, v234, v235
    v_max3_f32 v196, v196, v220, v221
    v_max3_f32 v197, v197, v236, v237
    v_max3_f32 v196, v196, v222, v223
    v_max3_f32 v197, v197, v238, v239
    s_sub_u32 s15, s15, 1
    s_cmp_lg_u32 s15, 0
    s_cbranch_scc1 L_fbl
    s_nop 0
    v_permlane32_swap_b32 v194, v195
    s_nop 1
    v_max_f32 v194, v194, v195
    v_sub_f32 v194, 0, v194
    v_cvt_pk_bf16_f32 v195, v194, 0
    v_lshlrev_b32 v195, 16, v195
    v_sub_f32 v195, v194, v195
    v_cvt_pk_bf16_f32 v17, v194, v195
    s_nop 0
    v_permlane32_swap_b32 v196, v197
    s_nop 1
    v_max_f32 v196, v196, v197
    v_sub_f32 v196, 0, v196
    v_cvt_pk_bf16_f32 v197, v196, 0
    v_lshlrev_b32 v197, 16, v197
    v_sub_f32 v197, v196, v197
    v_cvt_pk_bf16_f32 v157, v196, v197
    s_branch L_fbdone
.p2align 6
.type L_table,@object
L_table:
    .long 14592, 0, 272, 0
    .long 14608, 16, 128, 0
    .long 14624, 32, 352, 0
    .long 14640, 48, 368, 0
    .long 14736, 144, 368, 0
    .long 14752, 160, 368, 0
    .long 14768, 176, 368, 0
    .long 14784, 192, 368, 0
    .long 14800, 208, 368, 0
    .long 14816, 224, 368, 0
    .long 14832, 240, 368, 0
    .long 14848, 256, 368, 0
    .long 14656, 64, 368, 0
    .long 14672, 80, 368, 0
    .long 14688, 96, 368, 0
    .long 14704, 112, 368, 0
    .long 14864, 8, 280, 0
    .long 14944, 24, 136, 0
    .long 14960, 40, 360, 0
    .long 14960, 56, 376, 0
    .long 14720, 152, 376, 0
    .long 14944, 168, 376, 0
    .long 14960, 184, 376, 0
    .long 14960, 200, 376, 0
    .long 14960, 216, 376, 0
    .long 14960, 232, 376, 0
    .long 14960, 248, 376, 0
    .long 14960, 264, 376, 0
    .long 14960, 72, 376, 0
    .long 14960, 88, 376, 0
    .long 14960, 104, 376, 0
    .long 14960, 120, 376, 0
    .long 14880, 288, 592, 0
    .long 14896, 304, 448, 0
    .long 14912, 320, 352, 0
    .long 14928, 336, 368, 0
    .long 15056, 464, 368, 0
    .long 15072, 480, 368, 0
    .long 15088, 496, 368, 0
    .long 15104, 512, 368, 0
    .long 15120, 528, 368, 0
    .long 15136, 544, 368, 0
    .long 15152, 560, 368, 0
    .long 15168, 576, 368, 0
    .long 14976, 384, 368, 0
    .long 14992, 400, 368, 0
    .long 15008, 416, 368, 0
    .long 15024, 432, 368, 0
    .long 15184, 296, 600, 0
    .long 14944, 312, 456, 0
    .long 14960, 328, 360, 0
    .long 14960, 344, 376, 0
    .long 15040, 472, 376, 0
    .long 14944, 488, 376, 0
    .long 14960, 504, 376, 0
    .long 14960, 520, 376, 0
    .long 14960, 536, 376, 0
    .long 14960, 552, 376, 0
    .long 14960, 568, 376, 0
    .long 14960, 584, 376, 0
    .long 14960, 392, 376, 0
    .long 14960, 408, 376, 0
    .long 14960, 424, 376, 0
    .long 14960, 440, 376, 0
.fill (1024 - ((. - concat_heads__grouped_kv_mqa__grouped_kv_mqa__prompt_kernel) & 1023)) & 1023, 1, 0
L_codeend:
.size L_table, L_codeend-L_table
.section .rodata,"a"
.p2align 6
.amdhsa_kernel concat_heads__grouped_kv_mqa__grouped_kv_mqa__prompt_kernel
  .amdhsa_next_free_vgpr 256
  .amdhsa_next_free_sgpr 102
  .amdhsa_accum_offset 256
  .amdhsa_group_segment_fixed_size 0
  .amdhsa_kernarg_size 104
  .amdhsa_user_sgpr_count 2
  .amdhsa_user_sgpr_kernarg_segment_ptr 1
  .amdhsa_system_sgpr_workgroup_id_x 1
.end_amdhsa_kernel
```
